```python
import torch

def _softmax(x, axis=-1):
    return torch.softmax(x, dim=axis)
def _gelu(x):
    return torch.nn.functional.gelu(x, approximate="tanh")
def _silu(x):
    return torch.nn.functional.silu(x)
def _sigmoid(x):
    return torch.sigmoid(x)
def _layernorm(x, axis=-1, eps=1e-5):
    m = x.mean(dim=axis, keepdim=True)
    v = x.var(dim=axis, keepdim=True, unbiased=False)
    return (x - m) / torch.sqrt(v + eps)
def _scatter_add(tgt, idx, src, axis=0):
    return tgt.clone().index_add_(axis, idx, src)
def _segment_sum(src, seg, n):
    out = torch.zeros((n,) + src.shape[1:], dtype=src.dtype)
    return out.index_add_(0, seg, src)
def _pad(x, pw):
    flat = tuple(v for pair in reversed(pw) for v in pair)
    return torch.nn.functional.pad(x, flat)

kernel_name = 'standalone__deep_cross_pnn__recsys'

def setup_inputs():

    _w = (lambda a: (lambda t: t.to(torch.bfloat16) if t.is_floating_point() else t)(torch.as_tensor(a)))
    B, F, D, V = 4096, 100, 64, min(1000, 100000)
    H = 4 * D
    return {
        "idx": _w((lambda lo, hi, *s: torch.randint(lo, hi, s))(0, V, B, F).to(torch.int64)),
        "table": _w((lambda *s: torch.randn(*s, dtype=torch.bfloat16) * 1.6)(V, D) * (D ** -0.5)),
        "w_p": _w((lambda *s: torch.randn(*s, dtype=torch.bfloat16) * 0.05)(F * F) * ((F * F) ** -0.5)),
        "w1": _w((lambda *s: torch.randn(*s, dtype=torch.bfloat16) * 1.6)(F * D, H) * ((F * D) ** -0.5)),
        "b1": _w((lambda *s: torch.randn(*s, dtype=torch.bfloat16) * 1.6)(H) * 0.01),
        "w2": _w((lambda *s: torch.randn(*s, dtype=torch.bfloat16) * 0.05)(H) * (H ** -0.5)),
        "b2": _w((lambda *s: torch.randn(*s, dtype=torch.bfloat16) * 0.05)(1) * 0.01),
    }

def reference(idx, table, w_p, w1, b1, w2, b2):
    emb = table[idx]
    B = emb.shape[0]; F = emb.shape[1]; D = emb.shape[2]
    ip = torch.einsum('bid,bjd->bij', emb, emb)
    ip = ip.reshape(B, F * F)
    logit_p = ip @ w_p
    z = emb.reshape(B, F * D)
    h = _gelu(z @ w1 + b1)
    logit_d = h @ w2 + b2
    return logit_p + logit_d
```

```asm
; @launch kernel=standalone__deep_cross_pnn__recsys_kernel grid=(256,1,1) block=(512,1,1) lds=162816
; @launch kernel=fin_kernel grid=(16,1,1) block=(256,1,1) lds=0
.amdgcn_target "amdgcn-amd-amdhsa--gfx950"
.text
.globl standalone__deep_cross_pnn__recsys_kernel
.p2align 8
.type standalone__deep_cross_pnn__recsys_kernel,@function
standalone__deep_cross_pnn__recsys_kernel:
    s_cmp_ge_u32 s2, 256
    s_cbranch_scc1 L_end
    s_load_dwordx16 s[16:31], s[0:1], 0
    s_load_dwordx4 s[32:35], s[0:1], 64
    s_lshr_b32 s3, s2, 2
    s_and_b32 s4, s2, 3
    v_lshrrev_b32 v6, 6, v0
    v_and_b32 v1, 63, v0
    v_readfirstlane_b32 s5, v6
    v_and_b32 v2, 15, v0
    v_bfe_u32 v3, v0, 4, 2
    v_lshlrev_b32 v4, 4, v3
    s_mov_b32 s76, 0x05040100
    s_mov_b32 s77, 0x07060302
    s_mov_b32 s82, 0xc0135761
    s_mov_b32 s83, 0xbdd2d3e8
    s_waitcnt lgkmcnt(0)
    s_mov_b32 s36, s16
    s_and_b32 s37, s17, 0xffff
    s_mov_b32 s38, 1638400
    s_mov_b32 s39, 0x00020000
    s_mov_b32 s40, s18
    s_and_b32 s41, s19, 0xffff
    s_mov_b32 s42, 128000
    s_mov_b32 s43, 0x00020000
    s_mov_b32 s44, s20
    s_and_b32 s45, s21, 0xffff
    s_mov_b32 s46, 20000
    s_mov_b32 s47, 0x00020000
    s_mov_b32 s48, s22
    s_and_b32 s49, s23, 0xffff
    s_mov_b32 s50, 3276800
    s_mov_b32 s51, 0x00020000
    s_mov_b32 s52, s24
    s_and_b32 s53, s25, 0xffff
    s_mov_b32 s54, 512
    s_mov_b32 s55, 0x00020000
    s_mov_b32 s56, s26
    s_and_b32 s57, s27, 0xffff
    s_mov_b32 s58, 512
    s_mov_b32 s59, 0x00020000
    s_mov_b32 s72, s28
    s_and_b32 s73, s29, 0xffff
    s_mov_b32 s74, 2
    s_mov_b32 s75, 0x00020000
    s_mov_b32 s60, s34
    s_and_b32 s61, s35, 0xffff
    s_mov_b32 s62, 81920
    s_mov_b32 s63, 0x00020000
    s_mov_b32 s64, s32
    s_and_b32 s65, s33, 0xffff
    s_mov_b32 s66, 256
    s_mov_b32 s67, 0x00020000
    s_mov_b32 s68, s30
    s_and_b32 s69, s31, 0xffff
    s_mov_b32 s70, 8192
    s_mov_b32 s71, 0x00020000
    s_lshr_b32 s78, s3, 1
    s_mul_i32 s78, s78, 102400
    s_lshl_b32 s79, s4, 7
    s_add_u32 s78, s78, s79
    v_lshrrev_b32 v6, 3, v0
    v_and_b32 v7, 7, v0
    v_lshlrev_b32 v7, 4, v7
    v_lshl_or_b32 v6, v6, 9, v7
    buffer_load_dwordx4 v[100:103], v6, s[48:51], s78 offen
    s_add_u32 s78, s78, 32768
    buffer_load_dwordx4 v[104:107], v6, s[48:51], s78 offen
    s_add_u32 s78, s78, 32768
    buffer_load_dwordx4 v[108:111], v6, s[48:51], s78 offen
    s_add_u32 s78, s78, 32768
    buffer_load_dwordx4 v[112:115], v6, s[48:51], s78 offen
    s_add_u32 s78, s78, 32768
    v_lshlrev_b32 v7, 4, v1
    s_lshl_b32 s78, s5, 10
    s_add_u32 s79, s78, 128000
    s_mov_b32 m0, s79
    s_nop 0
    buffer_load_dwordx4 v7, s[44:47], s78 offen lds
    s_add_u32 s78, s78, 8192
    s_add_u32 s79, s78, 128000
    s_mov_b32 m0, s79
    s_nop 0
    buffer_load_dwordx4 v7, s[44:47], s78 offen lds
    s_add_u32 s78, s78, 8192
    s_add_u32 s79, s78, 128000
    s_mov_b32 m0, s79
    s_nop 0
    buffer_load_dwordx4 v7, s[44:47], s78 offen lds
    s_add_u32 s78, s78, 8192
    s_mul_i32 s89, s5, 12
    s_mul_i32 s79, s5, 13
    s_sub_u32 s79, s79, 4
    s_cmp_lt_u32 s5, 4
    s_cselect_b32 s89, s89, s79
    s_cselect_b32 s90, 12, 13
    s_mul_i32 s78, s3, 25600
    s_lshl_b32 s79, s89, 2
    s_add_u32 s78, s78, s79
    v_mul_u32_u24 v6, 400, v1
    buffer_load_dwordx4 v[16:19], v6, s[36:39], s78 offen offset:0
    buffer_load_dwordx4 v[20:23], v6, s[36:39], s78 offen offset:16
    buffer_load_dwordx4 v[24:27], v6, s[36:39], s78 offen offset:32
    buffer_load_dword v28, v6, s[36:39], s78 offen offset:48
    s_lshl_b32 s78, s3, 6
    s_lshl_b32 s79, s4, 4
    s_add_u32 s78, s78, s79
    s_lshl_b32 s79, s5, 1
    s_add_u32 s78, s78, s79
    s_mul_i32 s78, s78, 400
    v_lshlrev_b32 v7, 2, v1
    v_add_u32 v8, 64, v1
    v_min_u32 v8, 99, v8
    v_lshlrev_b32 v8, 2, v8
    buffer_load_dword v144, v7, s[36:39], s78 offen offset:0
    buffer_load_dword v145, v8, s[36:39], s78 offen offset:0
    buffer_load_dword v146, v7, s[36:39], s78 offen offset:400
    buffer_load_dword v147, v8, s[36:39], s78 offen offset:400
    s_and_b32 s79, s5, 1
    s_lshl_b32 s79, s79, 2
    v_lshrrev_b32 v9, 4, v1
    v_add_u32 v9, s79, v9
    v_and_b32 v10, 7, v1
    v_xor_b32 v10, v10, v9
    v_lshlrev_b32 v10, 4, v10
    v_lshrrev_b32 v9, 3, v1
    v_lshl_or_b32 v10, v9, 7, v10
    s_lshl_b32 s80, s5, 10
L_dma:
    s_mov_b32 m0, s80
    s_add_u32 s81, s80, 8192
    buffer_load_dwordx4 v10, s[40:43], s80 offen lds
    s_mov_b32 s80, s81
    s_cmp_lt_u32 s80, 128000
    s_cbranch_scc1 L_dma
    s_waitcnt vmcnt(15)
    s_barrier
    v_mul_u32_u24 v11, 200, v2
    v_lshl_add_u32 v11, v3, 3, v11
    v_add_u32 v11, 128000, v11
    v_mul_u32_u24 v14, 800, v3
    v_lshl_add_u32 v14, v2, 1, v14
    v_add_u32 v14, 128000, v14
    ds_read_b64 a[0:1], v11 offset:0
    ds_read_b64 a[2:3], v11 offset:3200
    ds_read_u16 v36, v14 offset:32
    ds_read_u16 v37, v14 offset:232
    ds_read_u16 v38, v14 offset:432
    ds_read_u16 v39, v14 offset:632
    ds_read_b64 a[4:5], v11 offset:6400
    ds_read_u16 v40, v14 offset:64
    ds_read_u16 v41, v14 offset:264
    ds_read_u16 v42, v14 offset:464
    ds_read_u16 v43, v14 offset:664
    ds_read_b64 a[6:7], v11 offset:9600
    ds_read_u16 v44, v14 offset:96
    ds_read_u16 v45, v14 offset:296
    ds_read_u16 v46, v14 offset:496
    ds_read_u16 v47, v14 offset:696
    ds_read_b64 a[8:9], v11 offset:12800
    ds_read_u16 v48, v14 offset:128
    ds_read_u16 v49, v14 offset:328
    ds_read_u16 v50, v14 offset:528
    ds_read_u16 v51, v14 offset:728
    ds_read_b64 a[10:11], v11 offset:16000
    ds_read_u16 v52, v14 offset:160
    ds_read_u16 v53, v14 offset:360
    ds_read_u16 v54, v14 offset:560
    ds_read_u16 v55, v14 offset:760
    ds_read_b64 a[12:13], v11 offset:19200
    ds_read_u16 v56, v14 offset:192
    ds_read_u16 v57, v14 offset:392
    ds_read_u16 v58, v14 offset:592
    ds_read_u16 v59, v14 offset:792
    ds_read_b64 a[14:15], v11 offset:3232
    ds_read_b64 a[16:17], v11 offset:6432
    ds_read_u16 v64, v14 offset:3264
    ds_read_u16 v65, v14 offset:3464
    ds_read_u16 v66, v14 offset:3664
    ds_read_u16 v67, v14 offset:3864
    ds_read_b64 a[18:19], v11 offset:9632
    ds_read_u16 v68, v14 offset:3296
    ds_read_u16 v69, v14 offset:3496
    ds_read_u16 v70, v14 offset:3696
    ds_read_u16 v71, v14 offset:3896
    ds_read_b64 a[20:21], v11 offset:12832
    ds_read_u16 v72, v14 offset:3328
    ds_read_u16 v73, v14 offset:3528
    ds_read_u16 v74, v14 offset:3728
    ds_read_u16 v75, v14 offset:3928
    ds_read_b64 a[22:23], v11 offset:16032
    ds_read_u16 v76, v14 offset:3360
    ds_read_u16 v77, v14 offset:3560
    ds_read_u16 v78, v14 offset:3760
    ds_read_u16 v79, v14 offset:3960
    ds_read_b64 a[24:25], v11 offset:19232
    ds_read_u16 v80, v14 offset:3392
    ds_read_u16 v81, v14 offset:3592
    ds_read_u16 v82, v14 offset:3792
    ds_read_u16 v83, v14 offset:3992
    ds_read_b64 a[26:27], v11 offset:6464
    ds_read_b64 a[28:29], v11 offset:9664
    ds_read_u16 v88, v14 offset:6496
    ds_read_u16 v89, v14 offset:6696
    ds_read_u16 v90, v14 offset:6896
    ds_read_u16 v91, v14 offset:7096
    ds_read_b64 a[30:31], v11 offset:12864
    ds_read_u16 v92, v14 offset:6528
    ds_read_u16 v93, v14 offset:6728
    ds_read_u16 v94, v14 offset:6928
    ds_read_u16 v95, v14 offset:7128
    ds_read_b64 a[32:33], v11 offset:16064
    ds_read_u16 v96, v14 offset:6560
    ds_read_u16 v97, v14 offset:6760
    ds_read_u16 v98, v14 offset:6960
    ds_read_u16 v99, v14 offset:7160
    ds_read_b64 a[34:35], v11 offset:19264
    ds_read_u16 v100, v14 offset:6592
    ds_read_u16 v101, v14 offset:6792
    ds_read_u16 v102, v14 offset:6992
    ds_read_u16 v103, v14 offset:7192
    ds_read_b64 a[36:37], v11 offset:9696
    ds_read_b64 a[38:39], v11 offset:12896
    ds_read_u16 v108, v14 offset:9728
    ds_read_u16 v109, v14 offset:9928
    ds_read_u16 v110, v14 offset:10128
    ds_read_u16 v111, v14 offset:10328
    ds_read_b64 a[40:41], v11 offset:16096
    ds_read_u16 v112, v14 offset:9760
    ds_read_u16 v113, v14 offset:9960
    ds_read_u16 v114, v14 offset:10160
    ds_read_u16 v115, v14 offset:10360
    ds_read_b64 a[42:43], v11 offset:19296
    ds_read_u16 v116, v14 offset:9792
    ds_read_u16 v117, v14 offset:9992
    ds_read_u16 v118, v14 offset:10192
    ds_read_u16 v119, v14 offset:10392
    ds_read_b64 a[44:45], v11 offset:12928
    ds_read_b64 a[46:47], v11 offset:16128
    ds_read_u16 v124, v14 offset:12960
    ds_read_u16 v125, v14 offset:13160
    ds_read_u16 v126, v14 offset:13360
    ds_read_u16 v127, v14 offset:13560
    ds_read_b64 a[48:49], v11 offset:19328
    ds_read_u16 v128, v14 offset:12992
    ds_read_u16 v129, v14 offset:13192
    ds_read_u16 v130, v14 offset:13392
    ds_read_u16 v131, v14 offset:13592
    ds_read_b64 a[50:51], v11 offset:16160
    ds_read_b64 a[52:53], v11 offset:19360
    ds_read_u16 v136, v14 offset:16192
    ds_read_u16 v137, v14 offset:16392
    ds_read_u16 v138, v14 offset:16592
    ds_read_u16 v139, v14 offset:16792
    ds_read_b64 a[54:55], v11 offset:19392
    v_cmp_gt_u32 s[92:93], 4, v2
    v_cmp_gt_u32 s[94:95], 4, v1
    s_waitcnt lgkmcnt(0)
    s_barrier
    s_mul_i32 s78, s5, 3328
    s_add_u32 s78, s78, 128000
    v_lshlrev_b32 v9, 4, v2
    v_lshl_add_u32 v9, v3, 2, v9
    v_add_u32 v9, s78, v9
    v_bfe_u32 v29, v16, 1, 3
    v_lshlrev_b32 v16, 7, v16
    v_lshl_or_b32 v16, v29, 4, v16
    ds_write_b32 v9, v16 offset:0
    v_bfe_u32 v29, v17, 1, 3
    v_lshlrev_b32 v17, 7, v17
    v_lshl_or_b32 v17, v29, 4, v17
    ds_write_b32 v9, v17 offset:256
    v_bfe_u32 v29, v18, 1, 3
    v_lshlrev_b32 v18, 7, v18
    v_lshl_or_b32 v18, v29, 4, v18
    ds_write_b32 v9, v18 offset:512
    v_bfe_u32 v29, v19, 1, 3
    v_lshlrev_b32 v19, 7, v19
    v_lshl_or_b32 v19, v29, 4, v19
    ds_write_b32 v9, v19 offset:768
    v_bfe_u32 v29, v20, 1, 3
    v_lshlrev_b32 v20, 7, v20
    v_lshl_or_b32 v20, v29, 4, v20
    ds_write_b32 v9, v20 offset:1024
    v_bfe_u32 v29, v21, 1, 3
    v_lshlrev_b32 v21, 7, v21
    v_lshl_or_b32 v21, v29, 4, v21
    ds_write_b32 v9, v21 offset:1280
    v_bfe_u32 v29, v22, 1, 3
    v_lshlrev_b32 v22, 7, v22
    v_lshl_or_b32 v22, v29, 4, v22
    ds_write_b32 v9, v22 offset:1536
    v_bfe_u32 v29, v23, 1, 3
    v_lshlrev_b32 v23, 7, v23
    v_lshl_or_b32 v23, v29, 4, v23
    ds_write_b32 v9, v23 offset:1792
    v_bfe_u32 v29, v24, 1, 3
    v_lshlrev_b32 v24, 7, v24
    v_lshl_or_b32 v24, v29, 4, v24
    ds_write_b32 v9, v24 offset:2048
    v_bfe_u32 v29, v25, 1, 3
    v_lshlrev_b32 v25, 7, v25
    v_lshl_or_b32 v25, v29, 4, v25
    ds_write_b32 v9, v25 offset:2304
    v_bfe_u32 v29, v26, 1, 3
    v_lshlrev_b32 v26, 7, v26
    v_lshl_or_b32 v26, v29, 4, v26
    ds_write_b32 v9, v26 offset:2560
    v_bfe_u32 v29, v27, 1, 3
    v_lshlrev_b32 v27, 7, v27
    v_lshl_or_b32 v27, v29, 4, v27
    ds_write_b32 v9, v27 offset:2816
    v_bfe_u32 v29, v28, 1, 3
    v_lshlrev_b32 v28, 7, v28
    v_lshl_or_b32 v28, v29, 4, v28
    ds_write_b32 v9, v28 offset:3072
    s_lshl_b32 s78, s5, 10
    s_add_u32 s78, s78, 154624
    v_lshlrev_b32 v9, 5, v2
    v_lshl_add_u32 v9, v3, 2, v9
    v_add_u32 v9, s78, v9
    v_bfe_u32 v29, v144, 1, 3
    v_lshlrev_b32 v144, 7, v144
    v_lshl_or_b32 v144, v29, 4, v144
    v_bfe_u32 v29, v145, 1, 3
    v_lshlrev_b32 v145, 7, v145
    v_lshl_or_b32 v145, v29, 4, v145
    ds_write_b32 v9, v144 offset:0
    ds_write_b32 v9, v145 offset:16
    v_bfe_u32 v29, v146, 1, 3
    v_lshlrev_b32 v146, 7, v146
    v_lshl_or_b32 v146, v29, 4, v146
    v_bfe_u32 v29, v147, 1, 3
    v_lshlrev_b32 v147, 7, v147
    v_lshl_or_b32 v147, v29, 4, v147
    ds_write_b32 v9, v146 offset:512
    ds_write_b32 v9, v147 offset:528
    s_waitcnt lgkmcnt(0)
    s_lshl_b32 s79, s4, 7
    v_and_b32 v13, 3, v2
    v_lshrrev_b32 v14, 3, v2
    v_lshl_add_u32 v13, v14, 2, v13
    v_bfe_u32 v14, v2, 2, 1
    v_lshlrev_b32 v11, 4, v13
    v_lshl_add_u32 v11, v14, 3, v11
    buffer_load_dwordx2 v[156:157], v11, s[52:55], s79 offen
    buffer_load_dwordx2 v[158:159], v11, s[56:59], s79 offen
    v_lshlrev_b32 v5, 12, v3
    v_lshl_add_u32 v5, v13, 4, v5
    v_lshl_add_u32 v5, v14, 11, v5
    s_lshl_b32 s79, s4, 7
    v_add_u32 v5, s79, v5
    s_lshl_b32 s86, s89, 15
    v_accvgpr_read_b32 v16, a0
    v_accvgpr_read_b32 v17, a1
    v_lshlrev_b32 v32, 16, v16
    v_and_b32 v33, 0xffff0000, v16
    v_lshlrev_b32 v34, 16, v17
    v_and_b32 v35, 0xffff0000, v17
    v_accvgpr_read_b32 v16, a2
    v_accvgpr_read_b32 v17, a3
    v_lshlrev_b32 v36, 16, v36
    v_lshlrev_b32 v37, 16, v37
    v_lshlrev_b32 v38, 16, v38
    v_lshlrev_b32 v39, 16, v39
    v_lshlrev_b32 v18, 16, v16
    v_and_b32 v19, 0xffff0000, v16
    v_lshlrev_b32 v20, 16, v17
    v_and_b32 v21, 0xffff0000, v17
    v_add_f32 v36, v36, v18
    v_add_f32 v37, v37, v19
    v_add_f32 v38, v38, v20
    v_add_f32 v39, v39, v21
    v_accvgpr_read_b32 v16, a4
    v_accvgpr_read_b32 v17, a5
    v_lshlrev_b32 v40, 16, v40
    v_lshlrev_b32 v41, 16, v41
    v_lshlrev_b32 v42, 16, v42
    v_lshlrev_b32 v43, 16, v43
    v_lshlrev_b32 v18, 16, v16
    v_and_b32 v19, 0xffff0000, v16
    v_lshlrev_b32 v20, 16, v17
    v_and_b32 v21, 0xffff0000, v17
    v_add_f32 v40, v40, v18
    v_add_f32 v41, v41, v19
    v_add_f32 v42, v42, v20
    v_add_f32 v43, v43, v21
    v_accvgpr_read_b32 v16, a6
    v_accvgpr_read_b32 v17, a7
    v_lshlrev_b32 v44, 16, v44
    v_lshlrev_b32 v45, 16, v45
    v_lshlrev_b32 v46, 16, v46
    v_lshlrev_b32 v47, 16, v47
    v_lshlrev_b32 v18, 16, v16
    v_and_b32 v19, 0xffff0000, v16
    v_lshlrev_b32 v20, 16, v17
    v_and_b32 v21, 0xffff0000, v17
    v_add_f32 v44, v44, v18
    v_add_f32 v45, v45, v19
    v_add_f32 v46, v46, v20
    v_add_f32 v47, v47, v21
    v_accvgpr_read_b32 v16, a8
    v_accvgpr_read_b32 v17, a9
    v_lshlrev_b32 v48, 16, v48
    v_lshlrev_b32 v49, 16, v49
    v_lshlrev_b32 v50, 16, v50
    v_lshlrev_b32 v51, 16, v51
    v_lshlrev_b32 v18, 16, v16
    v_and_b32 v19, 0xffff0000, v16
    v_lshlrev_b32 v20, 16, v17
    v_and_b32 v21, 0xffff0000, v17
    v_add_f32 v48, v48, v18
    v_add_f32 v49, v49, v19
    v_add_f32 v50, v50, v20
    v_add_f32 v51, v51, v21
    v_accvgpr_read_b32 v16, a10
    v_accvgpr_read_b32 v17, a11
    v_lshlrev_b32 v52, 16, v52
    v_lshlrev_b32 v53, 16, v53
    v_lshlrev_b32 v54, 16, v54
    v_lshlrev_b32 v55, 16, v55
    v_lshlrev_b32 v18, 16, v16
    v_and_b32 v19, 0xffff0000, v16
    v_lshlrev_b32 v20, 16, v17
    v_and_b32 v21, 0xffff0000, v17
    v_add_f32 v52, v52, v18
    v_add_f32 v53, v53, v19
    v_add_f32 v54, v54, v20
    v_add_f32 v55, v55, v21
    v_accvgpr_read_b32 v16, a12
    v_accvgpr_read_b32 v17, a13
    v_lshlrev_b32 v56, 16, v56
    v_lshlrev_b32 v57, 16, v57
    v_lshlrev_b32 v58, 16, v58
    v_lshlrev_b32 v59, 16, v59
    v_lshlrev_b32 v18, 16, v16
    v_and_b32 v19, 0xffff0000, v16
    v_lshlrev_b32 v20, 16, v17
    v_and_b32 v21, 0xffff0000, v17
    v_add_f32 v56, v56, v18
    v_add_f32 v57, v57, v19
    v_add_f32 v58, v58, v20
    v_add_f32 v59, v59, v21
    v_cndmask_b32 v56, 0, v56, s[92:93]
    v_cndmask_b32 v57, 0, v57, s[92:93]
    v_cndmask_b32 v58, 0, v58, s[92:93]
    v_cndmask_b32 v59, 0, v59, s[92:93]
    v_accvgpr_read_b32 v16, a14
    v_accvgpr_read_b32 v17, a15
    v_lshlrev_b32 v60, 16, v16
    v_and_b32 v61, 0xffff0000, v16
    v_lshlrev_b32 v62, 16, v17
    v_and_b32 v63, 0xffff0000, v17
    v_accvgpr_read_b32 v16, a16
    v_accvgpr_read_b32 v17, a17
    v_lshlrev_b32 v64, 16, v64
    v_lshlrev_b32 v65, 16, v65
    v_lshlrev_b32 v66, 16, v66
    v_lshlrev_b32 v67, 16, v67
    v_lshlrev_b32 v18, 16, v16
    v_and_b32 v19, 0xffff0000, v16
    v_lshlrev_b32 v20, 16, v17
    v_and_b32 v21, 0xffff0000, v17
    v_add_f32 v64, v64, v18
    v_add_f32 v65, v65, v19
    v_add_f32 v66, v66, v20
    v_add_f32 v67, v67, v21
    v_accvgpr_read_b32 v16, a18
    v_accvgpr_read_b32 v17, a19
    v_lshlrev_b32 v68, 16, v68
    v_lshlrev_b32 v69, 16, v69
    v_lshlrev_b32 v70, 16, v70
    v_lshlrev_b32 v71, 16, v71
    v_lshlrev_b32 v18, 16, v16
    v_and_b32 v19, 0xffff0000, v16
    v_lshlrev_b32 v20, 16, v17
    v_and_b32 v21, 0xffff0000, v17
    v_add_f32 v68, v68, v18
    v_add_f32 v69, v69, v19
    v_add_f32 v70, v70, v20
    v_add_f32 v71, v71, v21
    v_accvgpr_read_b32 v16, a20
    v_accvgpr_read_b32 v17, a21
    v_lshlrev_b32 v72, 16, v72
    v_lshlrev_b32 v73, 16, v73
    v_lshlrev_b32 v74, 16, v74
    v_lshlrev_b32 v75, 16, v75
    v_lshlrev_b32 v18, 16, v16
    v_and_b32 v19, 0xffff0000, v16
    v_lshlrev_b32 v20, 16, v17
    v_and_b32 v21, 0xffff0000, v17
    v_add_f32 v72, v72, v18
    v_add_f32 v73, v73, v19
    v_add_f32 v74, v74, v20
    v_add_f32 v75, v75, v21
    v_accvgpr_read_b32 v16, a22
    v_accvgpr_read_b32 v17, a23
    v_lshlrev_b32 v76, 16, v76
    v_lshlrev_b32 v77, 16, v77
    v_lshlrev_b32 v78, 16, v78
    v_lshlrev_b32 v79, 16, v79
    v_lshlrev_b32 v18, 16, v16
    v_and_b32 v19, 0xffff0000, v16
    v_lshlrev_b32 v20, 16, v17
    v_and_b32 v21, 0xffff0000, v17
    v_add_f32 v76, v76, v18
    v_add_f32 v77, v77, v19
    v_add_f32 v78, v78, v20
    v_add_f32 v79, v79, v21
    v_accvgpr_read_b32 v16, a24
    v_accvgpr_read_b32 v17, a25
    v_lshlrev_b32 v80, 16, v80
    v_lshlrev_b32 v81, 16, v81
    v_lshlrev_b32 v82, 16, v82
    v_lshlrev_b32 v83, 16, v83
    v_lshlrev_b32 v18, 16, v16
    v_and_b32 v19, 0xffff0000, v16
    v_lshlrev_b32 v20, 16, v17
    v_and_b32 v21, 0xffff0000, v17
    v_add_f32 v80, v80, v18
    v_add_f32 v81, v81, v19
    v_add_f32 v82, v82, v20
    v_add_f32 v83, v83, v21
    v_cndmask_b32 v80, 0, v80, s[92:93]
    v_cndmask_b32 v81, 0, v81, s[92:93]
    v_cndmask_b32 v82, 0, v82, s[92:93]
    v_cndmask_b32 v83, 0, v83, s[92:93]
    v_accvgpr_read_b32 v16, a26
    v_accvgpr_read_b32 v17, a27
    v_lshlrev_b32 v84, 16, v16
    v_and_b32 v85, 0xffff0000, v16
    v_lshlrev_b32 v86, 16, v17
    v_and_b32 v87, 0xffff0000, v17
    v_accvgpr_read_b32 v16, a28
    v_accvgpr_read_b32 v17, a29
    v_lshlrev_b32 v88, 16, v88
    v_lshlrev_b32 v89, 16, v89
    v_lshlrev_b32 v90, 16, v90
    v_lshlrev_b32 v91, 16, v91
    v_lshlrev_b32 v18, 16, v16
    v_and_b32 v19, 0xffff0000, v16
    v_lshlrev_b32 v20, 16, v17
    v_and_b32 v21, 0xffff0000, v17
    v_add_f32 v88, v88, v18
    v_add_f32 v89, v89, v19
    v_add_f32 v90, v90, v20
    v_add_f32 v91, v91, v21
    v_accvgpr_read_b32 v16, a30
    v_accvgpr_read_b32 v17, a31
    v_lshlrev_b32 v92, 16, v92
    v_lshlrev_b32 v93, 16, v93
    v_lshlrev_b32 v94, 16, v94
    v_lshlrev_b32 v95, 16, v95
    v_lshlrev_b32 v18, 16, v16
    v_and_b32 v19, 0xffff0000, v16
    v_lshlrev_b32 v20, 16, v17
    v_and_b32 v21, 0xffff0000, v17
    v_add_f32 v92, v92, v18
    v_add_f32 v93, v93, v19
    v_add_f32 v94, v94, v20
    v_add_f32 v95, v95, v21
    v_accvgpr_read_b32 v16, a32
    v_accvgpr_read_b32 v17, a33
    v_lshlrev_b32 v96, 16, v96
    v_lshlrev_b32 v97, 16, v97
    v_lshlrev_b32 v98, 16, v98
    v_lshlrev_b32 v99, 16, v99
    v_lshlrev_b32 v18, 16, v16
    v_and_b32 v19, 0xffff0000, v16
    v_lshlrev_b32 v20, 16, v17
    v_and_b32 v21, 0xffff0000, v17
    v_add_f32 v96, v96, v18
    v_add_f32 v97, v97, v19
    v_add_f32 v98, v98, v20
    v_add_f32 v99, v99, v21
    v_accvgpr_read_b32 v16, a34
    v_accvgpr_read_b32 v17, a35
    v_lshlrev_b32 v100, 16, v100
    v_lshlrev_b32 v101, 16, v101
    v_lshlrev_b32 v102, 16, v102
    v_lshlrev_b32 v103, 16, v103
    v_lshlrev_b32 v18, 16, v16
    v_and_b32 v19, 0xffff0000, v16
    v_lshlrev_b32 v20, 16, v17
    v_and_b32 v21, 0xffff0000, v17
    v_add_f32 v100, v100, v18
    v_add_f32 v101, v101, v19
    v_add_f32 v102, v102, v20
    v_add_f32 v103, v103, v21
    v_cndmask_b32 v100, 0, v100, s[92:93]
    v_cndmask_b32 v101, 0, v101, s[92:93]
    v_cndmask_b32 v102, 0, v102, s[92:93]
    v_cndmask_b32 v103, 0, v103, s[92:93]
    v_accvgpr_read_b32 v16, a36
    v_accvgpr_read_b32 v17, a37
    v_lshlrev_b32 v104, 16, v16
    v_and_b32 v105, 0xffff0000, v16
    v_lshlrev_b32 v106, 16, v17
    v_and_b32 v107, 0xffff0000, v17
    v_accvgpr_read_b32 v16, a38
    v_accvgpr_read_b32 v17, a39
    v_lshlrev_b32 v108, 16, v108
    v_lshlrev_b32 v109, 16, v109
    v_lshlrev_b32 v110, 16, v110
    v_lshlrev_b32 v111, 16, v111
    v_lshlrev_b32 v18, 16, v16
    v_and_b32 v19, 0xffff0000, v16
    v_lshlrev_b32 v20, 16, v17
    v_and_b32 v21, 0xffff0000, v17
    v_add_f32 v108, v108, v18
    v_add_f32 v109, v109, v19
    v_add_f32 v110, v110, v20
    v_add_f32 v111, v111, v21
    v_accvgpr_read_b32 v16, a40
    v_accvgpr_read_b32 v17, a41
    v_lshlrev_b32 v112, 16, v112
    v_lshlrev_b32 v113, 16, v113
    v_lshlrev_b32 v114, 16, v114
    v_lshlrev_b32 v115, 16, v115
    v_lshlrev_b32 v18, 16, v16
    v_and_b32 v19, 0xffff0000, v16
    v_lshlrev_b32 v20, 16, v17
    v_and_b32 v21, 0xffff0000, v17
    v_add_f32 v112, v112, v18
    v_add_f32 v113, v113, v19
    v_add_f32 v114, v114, v20
    v_add_f32 v115, v115, v21
    v_accvgpr_read_b32 v16, a42
    v_accvgpr_read_b32 v17, a43
    v_lshlrev_b32 v116, 16, v116
    v_lshlrev_b32 v117, 16, v117
    v_lshlrev_b32 v118, 16, v118
    v_lshlrev_b32 v119, 16, v119
    v_lshlrev_b32 v18, 16, v16
    v_and_b32 v19, 0xffff0000, v16
    v_lshlrev_b32 v20, 16, v17
    v_and_b32 v21, 0xffff0000, v17
    v_add_f32 v116, v116, v18
    v_add_f32 v117, v117, v19
    v_add_f32 v118, v118, v20
    v_add_f32 v119, v119, v21
    v_cndmask_b32 v116, 0, v116, s[92:93]
    v_cndmask_b32 v117, 0, v117, s[92:93]
    v_cndmask_b32 v118, 0, v118, s[92:93]
    v_cndmask_b32 v119, 0, v119, s[92:93]
    v_accvgpr_read_b32 v16, a44
    v_accvgpr_read_b32 v17, a45
    v_lshlrev_b32 v120, 16, v16
    v_and_b32 v121, 0xffff0000, v16
    v_lshlrev_b32 v122, 16, v17
    v_and_b32 v123, 0xffff0000, v17
    v_accvgpr_read_b32 v16, a46
    v_accvgpr_read_b32 v17, a47
    v_lshlrev_b32 v124, 16, v124
    v_lshlrev_b32 v125, 16, v125
    v_lshlrev_b32 v126, 16, v126
    v_lshlrev_b32 v127, 16, v127
    v_lshlrev_b32 v18, 16, v16
    v_and_b32 v19, 0xffff0000, v16
    v_lshlrev_b32 v20, 16, v17
    v_and_b32 v21, 0xffff0000, v17
    v_add_f32 v124, v124, v18
    v_add_f32 v125, v125, v19
    v_add_f32 v126, v126, v20
    v_add_f32 v127, v127, v21
    v_accvgpr_read_b32 v16, a48
    v_accvgpr_read_b32 v17, a49
    v_lshlrev_b32 v128, 16, v128
    v_lshlrev_b32 v129, 16, v129
    v_lshlrev_b32 v130, 16, v130
    v_lshlrev_b32 v131, 16, v131
    v_lshlrev_b32 v18, 16, v16
    v_and_b32 v19, 0xffff0000, v16
    v_lshlrev_b32 v20, 16, v17
    v_and_b32 v21, 0xffff0000, v17
    v_add_f32 v128, v128, v18
    v_add_f32 v129, v129, v19
    v_add_f32 v130, v130, v20
    v_add_f32 v131, v131, v21
    v_cndmask_b32 v128, 0, v128, s[92:93]
    v_cndmask_b32 v129, 0, v129, s[92:93]
    v_cndmask_b32 v130, 0, v130, s[92:93]
    v_cndmask_b32 v131, 0, v131, s[92:93]
    v_accvgpr_read_b32 v16, a50
    v_accvgpr_read_b32 v17, a51
    v_lshlrev_b32 v132, 16, v16
    v_and_b32 v133, 0xffff0000, v16
    v_lshlrev_b32 v134, 16, v17
    v_and_b32 v135, 0xffff0000, v17
    v_accvgpr_read_b32 v16, a52
    v_accvgpr_read_b32 v17, a53
    v_lshlrev_b32 v136, 16, v136
    v_lshlrev_b32 v137, 16, v137
    v_lshlrev_b32 v138, 16, v138
    v_lshlrev_b32 v139, 16, v139
    v_lshlrev_b32 v18, 16, v16
    v_and_b32 v19, 0xffff0000, v16
    v_lshlrev_b32 v20, 16, v17
    v_and_b32 v21, 0xffff0000, v17
    v_add_f32 v136, v136, v18
    v_add_f32 v137, v137, v19
    v_add_f32 v138, v138, v20
    v_add_f32 v139, v139, v21
    v_cndmask_b32 v136, 0, v136, s[92:93]
    v_cndmask_b32 v137, 0, v137, s[92:93]
    v_cndmask_b32 v138, 0, v138, s[92:93]
    v_cndmask_b32 v139, 0, v139, s[92:93]
    v_accvgpr_read_b32 v16, a54
    v_accvgpr_read_b32 v17, a55
    v_lshlrev_b32 v140, 16, v16
    v_and_b32 v141, 0xffff0000, v16
    v_lshlrev_b32 v142, 16, v17
    v_and_b32 v143, 0xffff0000, v17
    v_cndmask_b32 v140, 0, v140, s[94:95]
    v_cndmask_b32 v141, 0, v141, s[94:95]
    v_cndmask_b32 v142, 0, v142, s[94:95]
    v_cndmask_b32 v143, 0, v143, s[94:95]
    s_waitcnt vmcnt(0) lgkmcnt(0)
    s_barrier
    v_xor_b32 v15, 64, v4
    s_lshl_b32 s78, s5, 10
    s_add_u32 s78, s78, 154624
    v_lshlrev_b32 v9, 5, v2
    v_add_u32 v9, s78, v9
    s_lshl_b32 s78, s3, 6
    s_lshl_b32 s79, s4, 4
    s_add_u32 s78, s78, s79
    s_lshl_b32 s79, s5, 1
    s_add_u32 s78, s78, s79
    s_lshl_b32 s78, s78, 2
    s_add_u32 s80, s78, 65536
    v_mov_b32 v10, 0
    s_mov_b32 s87, 0
L_pnn:
    ds_read_b128 v[144:147], v9
    ds_read_b128 v[148:151], v9 offset:16
    v_mov_b32 v152, 0
    v_mov_b32 v153, 0
    v_mov_b32 v154, 0
    v_mov_b32 v155, 0
    v_add_u32 v9, 512, v9
    s_waitcnt lgkmcnt(0)
    v_xor_b32 v11, v144, v4
    v_xor_b32 v12, v144, v15
    ds_read_b128 a[0:3], v11
    ds_read_b128 a[4:7], v12
    v_xor_b32 v11, v145, v4
    v_xor_b32 v12, v145, v15
    ds_read_b128 a[8:11], v11
    ds_read_b128 a[12:15], v12
    v_xor_b32 v11, v146, v4
    v_xor_b32 v12, v146, v15
    ds_read_b128 a[16:19], v11
    ds_read_b128 a[20:23], v12
    v_xor_b32 v11, v147, v4
    v_xor_b32 v12, v147, v15
    ds_read_b128 a[24:27], v11
    ds_read_b128 a[28:31], v12
    v_xor_b32 v11, v148, v4
    v_xor_b32 v12, v148, v15
    ds_read_b128 a[32:35], v11
    ds_read_b128 a[36:39], v12
    v_xor_b32 v11, v149, v4
    v_xor_b32 v12, v149, v15
    ds_read_b128 a[40:43], v11
    ds_read_b128 a[44:47], v12
    v_xor_b32 v11, v150, v4
    v_xor_b32 v12, v150, v15
    ds_read_b128 a[48:51], v11
    ds_read_b128 a[52:55], v12
    s_waitcnt lgkmcnt(0)
    v_mfma_f32_16x16x32_bf16 v[16:19], a[0:3], a[0:3], 0
    v_mfma_f32_16x16x32_bf16 v[16:19], a[4:7], a[4:7], v[16:19]
    v_mfma_f32_16x16x32_bf16 v[20:23], a[0:3], a[8:11], 0
    v_mfma_f32_16x16x32_bf16 v[20:23], a[4:7], a[12:15], v[20:23]
    v_mfma_f32_16x16x32_bf16 v[24:27], a[0:3], a[16:19], 0
    v_mfma_f32_16x16x32_bf16 v[24:27], a[4:7], a[20:23], v[24:27]
    v_mfma_f32_16x16x32_bf16 v[28:31], a[0:3], a[24:27], 0
    v_mfma_f32_16x16x32_bf16 v[28:31], a[4:7], a[28:31], v[28:31]
    v_fmac_f32 v152, v16, v32
    v_fmac_f32 v153, v17, v33
    v_fmac_f32 v154, v18, v34
    v_fmac_f32 v155, v19, v35
    v_mfma_f32_16x16x32_bf16 v[16:19], a[0:3], a[32:35], 0
    v_mfma_f32_16x16x32_bf16 v[16:19], a[4:7], a[36:39], v[16:19]
    v_fmac_f32 v152, v20, v36
    v_fmac_f32 v153, v21, v37
    v_fmac_f32 v154, v22, v38
    v_fmac_f32 v155, v23, v39
    v_mfma_f32_16x16x32_bf16 v[20:23], a[0:3], a[40:43], 0
    v_mfma_f32_16x16x32_bf16 v[20:23], a[4:7], a[44:47], v[20:23]
    v_fmac_f32 v152, v24, v40
    v_fmac_f32 v153, v25, v41
    v_fmac_f32 v154, v26, v42
    v_fmac_f32 v155, v27, v43
    v_mfma_f32_16x16x32_bf16 v[24:27], a[0:3], a[48:51], 0
    v_mfma_f32_16x16x32_bf16 v[24:27], a[4:7], a[52:55], v[24:27]
    v_fmac_f32 v152, v28, v44
    v_fmac_f32 v153, v29, v45
    v_fmac_f32 v154, v30, v46
    v_fmac_f32 v155, v31, v47
    v_mfma_f32_16x16x32_bf16 v[28:31], a[8:11], a[8:11], 0
    v_mfma_f32_16x16x32_bf16 v[28:31], a[12:15], a[12:15], v[28:31]
    v_fmac_f32 v152, v16, v48
    v_fmac_f32 v153, v17, v49
    v_fmac_f32 v154, v18, v50
    v_fmac_f32 v155, v19, v51
    v_mfma_f32_16x16x32_bf16 v[16:19], a[8:11], a[16:19], 0
    v_mfma_f32_16x16x32_bf16 v[16:19], a[12:15], a[20:23], v[16:19]
    v_fmac_f32 v152, v20, v52
    v_fmac_f32 v153, v21, v53
    v_fmac_f32 v154, v22, v54
    v_fmac_f32 v155, v23, v55
    v_mfma_f32_16x16x32_bf16 v[20:23], a[8:11], a[24:27], 0
    v_mfma_f32_16x16x32_bf16 v[20:23], a[12:15], a[28:31], v[20:23]
    v_fmac_f32 v152, v24, v56
    v_fmac_f32 v153, v25, v57
    v_fmac_f32 v154, v26, v58
    v_fmac_f32 v155, v27, v59
    v_mfma_f32_16x16x32_bf16 v[24:27], a[8:11], a[32:35], 0
    v_mfma_f32_16x16x32_bf16 v[24:27], a[12:15], a[36:39], v[24:27]
    v_fmac_f32 v152, v28, v60
    v_fmac_f32 v153, v29, v61
    v_fmac_f32 v154, v30, v62
    v_fmac_f32 v155, v31, v63
    v_mfma_f32_16x16x32_bf16 v[28:31], a[8:11], a[40:43], 0
    v_mfma_f32_16x16x32_bf16 v[28:31], a[12:15], a[44:47], v[28:31]
    v_fmac_f32 v152, v16, v64
    v_fmac_f32 v153, v17, v65
    v_fmac_f32 v154, v18, v66
    v_fmac_f32 v155, v19, v67
    v_mfma_f32_16x16x32_bf16 v[16:19], a[8:11], a[48:51], 0
    v_mfma_f32_16x16x32_bf16 v[16:19], a[12:15], a[52:55], v[16:19]
    v_fmac_f32 v152, v20, v68
    v_fmac_f32 v153, v21, v69
    v_fmac_f32 v154, v22, v70
    v_fmac_f32 v155, v23, v71
    v_mfma_f32_16x16x32_bf16 v[20:23], a[16:19], a[16:19], 0
    v_mfma_f32_16x16x32_bf16 v[20:23], a[20:23], a[20:23], v[20:23]
    v_fmac_f32 v152, v24, v72
    v_fmac_f32 v153, v25, v73
    v_fmac_f32 v154, v26, v74
    v_fmac_f32 v155, v27, v75
    v_mfma_f32_16x16x32_bf16 v[24:27], a[16:19], a[24:27], 0
    v_mfma_f32_16x16x32_bf16 v[24:27], a[20:23], a[28:31], v[24:27]
    v_fmac_f32 v152, v28, v76
    v_fmac_f32 v153, v29, v77
    v_fmac_f32 v154, v30, v78
    v_fmac_f32 v155, v31, v79
    v_mfma_f32_16x16x32_bf16 v[28:31], a[16:19], a[32:35], 0
    v_mfma_f32_16x16x32_bf16 v[28:31], a[20:23], a[36:39], v[28:31]
    v_fmac_f32 v152, v16, v80
    v_fmac_f32 v153, v17, v81
    v_fmac_f32 v154, v18, v82
    v_fmac_f32 v155, v19, v83
    v_mfma_f32_16x16x32_bf16 v[16:19], a[16:19], a[40:43], 0
    v_mfma_f32_16x16x32_bf16 v[16:19], a[20:23], a[44:47], v[16:19]
    v_fmac_f32 v152, v20, v84
    v_fmac_f32 v153, v21, v85
    v_fmac_f32 v154, v22, v86
    v_fmac_f32 v155, v23, v87
    v_mfma_f32_16x16x32_bf16 v[20:23], a[16:19], a[48:51], 0
    v_mfma_f32_16x16x32_bf16 v[20:23], a[20:23], a[52:55], v[20:23]
    v_fmac_f32 v152, v24, v88
    v_fmac_f32 v153, v25, v89
    v_fmac_f32 v154, v26, v90
    v_fmac_f32 v155, v27, v91
    v_mfma_f32_16x16x32_bf16 v[24:27], a[24:27], a[24:27], 0
    v_mfma_f32_16x16x32_bf16 v[24:27], a[28:31], a[28:31], v[24:27]
    v_fmac_f32 v152, v28, v92
    v_fmac_f32 v153, v29, v93
    v_fmac_f32 v154, v30, v94
    v_fmac_f32 v155, v31, v95
    v_mfma_f32_16x16x32_bf16 v[28:31], a[24:27], a[32:35], 0
    v_mfma_f32_16x16x32_bf16 v[28:31], a[28:31], a[36:39], v[28:31]
    v_fmac_f32 v152, v16, v96
    v_fmac_f32 v153, v17, v97
    v_fmac_f32 v154, v18, v98
    v_fmac_f32 v155, v19, v99
    v_mfma_f32_16x16x32_bf16 v[16:19], a[24:27], a[40:43], 0
    v_mfma_f32_16x16x32_bf16 v[16:19], a[28:31], a[44:47], v[16:19]
    v_fmac_f32 v152, v20, v100
    v_fmac_f32 v153, v21, v101
    v_fmac_f32 v154, v22, v102
    v_fmac_f32 v155, v23, v103
    v_mfma_f32_16x16x32_bf16 v[20:23], a[24:27], a[48:51], 0
    v_mfma_f32_16x16x32_bf16 v[20:23], a[28:31], a[52:55], v[20:23]
    v_fmac_f32 v152, v24, v104
    v_fmac_f32 v153, v25, v105
    v_fmac_f32 v154, v26, v106
    v_fmac_f32 v155, v27, v107
    v_mfma_f32_16x16x32_bf16 v[24:27], a[32:35], a[32:35], 0
    v_mfma_f32_16x16x32_bf16 v[24:27], a[36:39], a[36:39], v[24:27]
    v_fmac_f32 v152, v28, v108
    v_fmac_f32 v153, v29, v109
    v_fmac_f32 v154, v30, v110
    v_fmac_f32 v155, v31, v111
    v_mfma_f32_16x16x32_bf16 v[28:31], a[32:35], a[40:43], 0
    v_mfma_f32_16x16x32_bf16 v[28:31], a[36:39], a[44:47], v[28:31]
    v_fmac_f32 v152, v16, v112
    v_fmac_f32 v153, v17, v113
    v_fmac_f32 v154, v18, v114
    v_fmac_f32 v155, v19, v115
    v_mfma_f32_16x16x32_bf16 v[16:19], a[32:35], a[48:51], 0
    v_mfma_f32_16x16x32_bf16 v[16:19], a[36:39], a[52:55], v[16:19]
    v_fmac_f32 v152, v20, v116
    v_fmac_f32 v153, v21, v117
    v_fmac_f32 v154, v22, v118
    v_fmac_f32 v155, v23, v119
    v_mfma_f32_16x16x32_bf16 v[20:23], a[40:43], a[40:43], 0
    v_mfma_f32_16x16x32_bf16 v[20:23], a[44:47], a[44:47], v[20:23]
    v_fmac_f32 v152, v24, v120
    v_fmac_f32 v153, v25, v121
    v_fmac_f32 v154, v26, v122
    v_fmac_f32 v155, v27, v123
    v_mfma_f32_16x16x32_bf16 v[24:27], a[40:43], a[48:51], 0
    v_mfma_f32_16x16x32_bf16 v[24:27], a[44:47], a[52:55], v[24:27]
    v_fmac_f32 v152, v28, v124
    v_fmac_f32 v153, v29, v125
    v_fmac_f32 v154, v30, v126
    v_fmac_f32 v155, v31, v127
    v_mfma_f32_16x16x32_bf16 v[28:31], a[48:51], a[48:51], 0
    v_mfma_f32_16x16x32_bf16 v[28:31], a[52:55], a[52:55], v[28:31]
    v_fmac_f32 v152, v16, v128
    v_fmac_f32 v153, v17, v129
    v_fmac_f32 v154, v18, v130
    v_fmac_f32 v155, v19, v131
    s_nop 3
    v_fmac_f32 v152, v20, v132
    v_fmac_f32 v153, v21, v133
    v_fmac_f32 v154, v22, v134
    v_fmac_f32 v155, v23, v135
    s_nop 3
    v_fmac_f32 v152, v24, v136
    v_fmac_f32 v153, v25, v137
    v_fmac_f32 v154, v26, v138
    v_fmac_f32 v155, v27, v139
    s_nop 3
    v_fmac_f32 v152, v28, v140
    v_fmac_f32 v153, v29, v141
    v_fmac_f32 v154, v30, v142
    v_fmac_f32 v155, v31, v143
    v_add_f32 v152, v152, v153
    v_add_f32 v154, v154, v155
    v_add_f32 v152, v152, v154
    s_nop 1
    v_add_f32_dpp v152, v152, v152 row_shr:1 row_mask:0xf bank_mask:0xf bound_ctrl:0
    s_nop 1
    v_add_f32_dpp v152, v152, v152 row_shr:2 row_mask:0xf bank_mask:0xf bound_ctrl:0
    s_nop 1
    v_add_f32_dpp v152, v152, v152 row_shr:4 row_mask:0xf bank_mask:0xf bound_ctrl:0
    s_nop 1
    v_add_f32_dpp v152, v152, v152 row_shr:8 row_mask:0xf bank_mask:0xf bound_ctrl:0
    s_nop 1
    v_add_f32_dpp v152, v152, v152 row_bcast:15 row_mask:0xa bank_mask:0xf
    s_nop 1
    v_add_f32_dpp v152, v152, v152 row_bcast:31 row_mask:0xc bank_mask:0xf
    s_mov_b32 exec_lo, 0
    s_mov_b32 exec_hi, 0x80000000
    buffer_store_dword v152, v10, s[60:63], s80 offen
    s_mov_b64 exec, -1
    s_add_u32 s80, s80, 4
    s_add_u32 s87, s87, 1
    s_cmp_lt_u32 s87, 2
    s_cbranch_scc1 L_pnn
    s_mul_i32 s78, s5, 3328
    s_add_u32 s78, s78, 128000
    v_lshlrev_b32 v9, 4, v2
    v_add_u32 v9, s78, v9
    ds_read_b128 v[144:147], v9
    s_mov_b32 s88, s86
    s_add_u32 s81, s88, 0
    buffer_load_dwordx4 v[64:67], v5, s[48:51], s81 offen offset:0
    buffer_load_dwordx4 v[68:71], v5, s[48:51], s81 offen offset:512
    buffer_load_dwordx4 v[72:75], v5, s[48:51], s81 offen offset:1024
    buffer_load_dwordx4 v[76:79], v5, s[48:51], s81 offen offset:1536
    s_add_u32 s81, s88, 16384
    buffer_load_dwordx4 v[80:83], v5, s[48:51], s81 offen offset:0
    buffer_load_dwordx4 v[84:87], v5, s[48:51], s81 offen offset:512
    buffer_load_dwordx4 v[88:91], v5, s[48:51], s81 offen offset:1024
    buffer_load_dwordx4 v[92:95], v5, s[48:51], s81 offen offset:1536
    s_add_u32 s81, s88, 32768
    buffer_load_dwordx4 v[96:99], v5, s[48:51], s81 offen offset:0
    buffer_load_dwordx4 v[100:103], v5, s[48:51], s81 offen offset:512
    buffer_load_dwordx4 v[104:107], v5, s[48:51], s81 offen offset:1024
    buffer_load_dwordx4 v[108:111], v5, s[48:51], s81 offen offset:1536
    s_add_u32 s81, s88, 49152
    buffer_load_dwordx4 v[112:115], v5, s[48:51], s81 offen offset:0
    buffer_load_dwordx4 v[116:119], v5, s[48:51], s81 offen offset:512
    buffer_load_dwordx4 v[120:123], v5, s[48:51], s81 offen offset:1024
    buffer_load_dwordx4 v[124:127], v5, s[48:51], s81 offen offset:1536
    s_add_u32 s88, s88, 65536
    v_accvgpr_write_b32 a0, 0
    v_accvgpr_write_b32 a1, 0
    v_accvgpr_write_b32 a2, 0
    v_accvgpr_write_b32 a3, 0
    v_accvgpr_write_b32 a4, 0
    v_accvgpr_write_b32 a5, 0
    v_accvgpr_write_b32 a6, 0
    v_accvgpr_write_b32 a7, 0
    v_accvgpr_write_b32 a8, 0
    v_accvgpr_write_b32 a9, 0
    v_accvgpr_write_b32 a10, 0
    v_accvgpr_write_b32 a11, 0
    v_accvgpr_write_b32 a12, 0
    v_accvgpr_write_b32 a13, 0
    v_accvgpr_write_b32 a14, 0
    v_accvgpr_write_b32 a15, 0
    v_accvgpr_write_b32 a16, 0
    v_accvgpr_write_b32 a17, 0
    v_accvgpr_write_b32 a18, 0
    v_accvgpr_write_b32 a19, 0
    v_accvgpr_write_b32 a20, 0
    v_accvgpr_write_b32 a21, 0
    v_accvgpr_write_b32 a22, 0
    v_accvgpr_write_b32 a23, 0
    v_accvgpr_write_b32 a24, 0
    v_accvgpr_write_b32 a25, 0
    v_accvgpr_write_b32 a26, 0
    v_accvgpr_write_b32 a27, 0
    v_accvgpr_write_b32 a28, 0
    v_accvgpr_write_b32 a29, 0
    v_accvgpr_write_b32 a30, 0
    v_accvgpr_write_b32 a31, 0
    v_accvgpr_write_b32 a32, 0
    v_accvgpr_write_b32 a33, 0
    v_accvgpr_write_b32 a34, 0
    v_accvgpr_write_b32 a35, 0
    v_accvgpr_write_b32 a36, 0
    v_accvgpr_write_b32 a37, 0
    v_accvgpr_write_b32 a38, 0
    v_accvgpr_write_b32 a39, 0
    v_accvgpr_write_b32 a40, 0
    v_accvgpr_write_b32 a41, 0
    v_accvgpr_write_b32 a42, 0
    v_accvgpr_write_b32 a43, 0
    v_accvgpr_write_b32 a44, 0
    v_accvgpr_write_b32 a45, 0
    v_accvgpr_write_b32 a46, 0
    v_accvgpr_write_b32 a47, 0
    v_accvgpr_write_b32 a48, 0
    v_accvgpr_write_b32 a49, 0
    v_accvgpr_write_b32 a50, 0
    v_accvgpr_write_b32 a51, 0
    v_accvgpr_write_b32 a52, 0
    v_accvgpr_write_b32 a53, 0
    v_accvgpr_write_b32 a54, 0
    v_accvgpr_write_b32 a55, 0
    v_accvgpr_write_b32 a56, 0
    v_accvgpr_write_b32 a57, 0
    v_accvgpr_write_b32 a58, 0
    v_accvgpr_write_b32 a59, 0
    v_accvgpr_write_b32 a60, 0
    v_accvgpr_write_b32 a61, 0
    v_accvgpr_write_b32 a62, 0
    v_accvgpr_write_b32 a63, 0
    s_mov_b32 s87, 0
L_mlp:
    s_waitcnt lgkmcnt(0)
    v_xor_b32 v16, v144, v4
    v_xor_b32 v17, v144, v15
    ds_read_b128 a[64:67], v16
    ds_read_b128 a[68:71], v17
    v_xor_b32 v18, v145, v4
    v_xor_b32 v19, v145, v15
    ds_read_b128 a[72:75], v18
    ds_read_b128 a[76:79], v19
    v_xor_b32 v20, v146, v4
    v_xor_b32 v21, v146, v15
    ds_read_b128 a[80:83], v20
    ds_read_b128 a[84:87], v21
    v_xor_b32 v22, v147, v4
    v_xor_b32 v23, v147, v15
    ds_read_b128 a[88:91], v22
    ds_read_b128 a[92:95], v23
    ds_read_b128 v[148:151], v9 offset:256
    v_add_u32 v9, 256, v9
    s_add_u32 s78, s87, 2
    s_cmp_ge_u32 s78, s90
    s_cselect_b32 s88, 0x40000000, s88
    s_waitcnt vmcnt(8)
    v_perm_b32 v32, v68, v64, s76
    v_perm_b32 v33, v76, v72, s76
    v_perm_b32 v36, v68, v64, s77
    v_perm_b32 v37, v76, v72, s77
    v_perm_b32 v40, v69, v65, s76
    v_perm_b32 v41, v77, v73, s76
    v_perm_b32 v44, v69, v65, s77
    v_perm_b32 v45, v77, v73, s77
    v_perm_b32 v128, v70, v66, s76
    v_perm_b32 v129, v78, v74, s76
    v_perm_b32 v130, v70, v66, s77
    v_perm_b32 v131, v78, v74, s77
    v_perm_b32 v132, v71, v67, s76
    v_perm_b32 v133, v79, v75, s76
    v_perm_b32 v134, v71, v67, s77
    v_perm_b32 v135, v79, v75, s77
    v_mov_b32_dpp v34, v32 row_shl:4 row_mask:0xf bank_mask:0x5
    v_mov_b32_dpp v35, v33 row_shl:4 row_mask:0xf bank_mask:0x5
    v_mov_b32_dpp v38, v36 row_shl:4 row_mask:0xf bank_mask:0x5
    v_mov_b32_dpp v39, v37 row_shl:4 row_mask:0xf bank_mask:0x5
    v_mov_b32_dpp v42, v40 row_shl:4 row_mask:0xf bank_mask:0x5
    v_mov_b32_dpp v43, v41 row_shl:4 row_mask:0xf bank_mask:0x5
    v_mov_b32_dpp v46, v44 row_shl:4 row_mask:0xf bank_mask:0x5
    v_mov_b32_dpp v47, v45 row_shl:4 row_mask:0xf bank_mask:0x5
    v_mov_b32_dpp v34, v128 quad_perm:[0,1,2,3] row_mask:0xf bank_mask:0xa
    v_mov_b32_dpp v35, v129 quad_perm:[0,1,2,3] row_mask:0xf bank_mask:0xa
    v_mov_b32_dpp v38, v130 quad_perm:[0,1,2,3] row_mask:0xf bank_mask:0xa
    v_mov_b32_dpp v39, v131 quad_perm:[0,1,2,3] row_mask:0xf bank_mask:0xa
    v_mov_b32_dpp v42, v132 quad_perm:[0,1,2,3] row_mask:0xf bank_mask:0xa
    v_mov_b32_dpp v43, v133 quad_perm:[0,1,2,3] row_mask:0xf bank_mask:0xa
    v_mov_b32_dpp v46, v134 quad_perm:[0,1,2,3] row_mask:0xf bank_mask:0xa
    v_mov_b32_dpp v47, v135 quad_perm:[0,1,2,3] row_mask:0xf bank_mask:0xa
    v_mov_b32_dpp v32, v128 row_shr:4 row_mask:0xf bank_mask:0xa
    v_mov_b32_dpp v33, v129 row_shr:4 row_mask:0xf bank_mask:0xa
    v_mov_b32_dpp v36, v130 row_shr:4 row_mask:0xf bank_mask:0xa
    v_mov_b32_dpp v37, v131 row_shr:4 row_mask:0xf bank_mask:0xa
    v_mov_b32_dpp v40, v132 row_shr:4 row_mask:0xf bank_mask:0xa
    v_mov_b32_dpp v41, v133 row_shr:4 row_mask:0xf bank_mask:0xa
    v_mov_b32_dpp v44, v134 row_shr:4 row_mask:0xf bank_mask:0xa
    v_mov_b32_dpp v45, v135 row_shr:4 row_mask:0xf bank_mask:0xa
    v_perm_b32 v48, v84, v80, s76
    v_perm_b32 v49, v92, v88, s76
    v_perm_b32 v52, v84, v80, s77
    v_perm_b32 v53, v92, v88, s77
    v_perm_b32 v56, v85, v81, s76
    v_perm_b32 v57, v93, v89, s76
    v_perm_b32 v60, v85, v81, s77
    v_perm_b32 v61, v93, v89, s77
    v_perm_b32 v128, v86, v82, s76
    v_perm_b32 v129, v94, v90, s76
    v_perm_b32 v130, v86, v82, s77
    v_perm_b32 v131, v94, v90, s77
    v_perm_b32 v132, v87, v83, s76
    v_perm_b32 v133, v95, v91, s76
    v_perm_b32 v134, v87, v83, s77
    v_perm_b32 v135, v95, v91, s77
    v_mov_b32_dpp v50, v48 row_shl:4 row_mask:0xf bank_mask:0x5
    v_mov_b32_dpp v51, v49 row_shl:4 row_mask:0xf bank_mask:0x5
    v_mov_b32_dpp v54, v52 row_shl:4 row_mask:0xf bank_mask:0x5
    v_mov_b32_dpp v55, v53 row_shl:4 row_mask:0xf bank_mask:0x5
    v_mov_b32_dpp v58, v56 row_shl:4 row_mask:0xf bank_mask:0x5
    v_mov_b32_dpp v59, v57 row_shl:4 row_mask:0xf bank_mask:0x5
    v_mov_b32_dpp v62, v60 row_shl:4 row_mask:0xf bank_mask:0x5
    v_mov_b32_dpp v63, v61 row_shl:4 row_mask:0xf bank_mask:0x5
    v_mov_b32_dpp v50, v128 quad_perm:[0,1,2,3] row_mask:0xf bank_mask:0xa
    v_mov_b32_dpp v51, v129 quad_perm:[0,1,2,3] row_mask:0xf bank_mask:0xa
    v_mov_b32_dpp v54, v130 quad_perm:[0,1,2,3] row_mask:0xf bank_mask:0xa
    v_mov_b32_dpp v55, v131 quad_perm:[0,1,2,3] row_mask:0xf bank_mask:0xa
    v_mov_b32_dpp v58, v132 quad_perm:[0,1,2,3] row_mask:0xf bank_mask:0xa
    v_mov_b32_dpp v59, v133 quad_perm:[0,1,2,3] row_mask:0xf bank_mask:0xa
    v_mov_b32_dpp v62, v134 quad_perm:[0,1,2,3] row_mask:0xf bank_mask:0xa
    v_mov_b32_dpp v63, v135 quad_perm:[0,1,2,3] row_mask:0xf bank_mask:0xa
    v_mov_b32_dpp v48, v128 row_shr:4 row_mask:0xf bank_mask:0xa
    v_mov_b32_dpp v49, v129 row_shr:4 row_mask:0xf bank_mask:0xa
    v_mov_b32_dpp v52, v130 row_shr:4 row_mask:0xf bank_mask:0xa
    v_mov_b32_dpp v53, v131 row_shr:4 row_mask:0xf bank_mask:0xa
    v_mov_b32_dpp v56, v132 row_shr:4 row_mask:0xf bank_mask:0xa
    v_mov_b32_dpp v57, v133 row_shr:4 row_mask:0xf bank_mask:0xa
    v_mov_b32_dpp v60, v134 row_shr:4 row_mask:0xf bank_mask:0xa
    v_mov_b32_dpp v61, v135 row_shr:4 row_mask:0xf bank_mask:0xa
    s_add_u32 s81, s88, 0
    buffer_load_dwordx4 v[64:67], v5, s[48:51], s81 offen offset:0
    buffer_load_dwordx4 v[68:71], v5, s[48:51], s81 offen offset:512
    buffer_load_dwordx4 v[72:75], v5, s[48:51], s81 offen offset:1024
    buffer_load_dwordx4 v[76:79], v5, s[48:51], s81 offen offset:1536
    s_add_u32 s81, s88, 16384
    buffer_load_dwordx4 v[80:83], v5, s[48:51], s81 offen offset:0
    buffer_load_dwordx4 v[84:87], v5, s[48:51], s81 offen offset:512
    buffer_load_dwordx4 v[88:91], v5, s[48:51], s81 offen offset:1024
    buffer_load_dwordx4 v[92:95], v5, s[48:51], s81 offen offset:1536
    s_add_u32 s88, s88, 32768
    s_waitcnt lgkmcnt(1)
    v_mfma_f32_16x16x32_bf16 a[0:3], a[64:67], v[32:35], a[0:3]
    v_mfma_f32_16x16x32_bf16 a[4:7], a[64:67], v[36:39], a[4:7]
    v_mfma_f32_16x16x32_bf16 a[8:11], a[64:67], v[40:43], a[8:11]
    v_mfma_f32_16x16x32_bf16 a[12:15], a[64:67], v[44:47], a[12:15]
    v_mfma_f32_16x16x32_bf16 a[16:19], a[72:75], v[32:35], a[16:19]
    v_mfma_f32_16x16x32_bf16 a[20:23], a[72:75], v[36:39], a[20:23]
    v_mfma_f32_16x16x32_bf16 a[24:27], a[72:75], v[40:43], a[24:27]
    v_mfma_f32_16x16x32_bf16 a[28:31], a[72:75], v[44:47], a[28:31]
    v_mfma_f32_16x16x32_bf16 a[32:35], a[80:83], v[32:35], a[32:35]
    v_mfma_f32_16x16x32_bf16 a[36:39], a[80:83], v[36:39], a[36:39]
    v_mfma_f32_16x16x32_bf16 a[40:43], a[80:83], v[40:43], a[40:43]
    v_mfma_f32_16x16x32_bf16 a[44:47], a[80:83], v[44:47], a[44:47]
    v_mfma_f32_16x16x32_bf16 a[48:51], a[88:91], v[32:35], a[48:51]
    v_mfma_f32_16x16x32_bf16 a[52:55], a[88:91], v[36:39], a[52:55]
    v_mfma_f32_16x16x32_bf16 a[56:59], a[88:91], v[40:43], a[56:59]
    v_mfma_f32_16x16x32_bf16 a[60:63], a[88:91], v[44:47], a[60:63]
    v_mfma_f32_16x16x32_bf16 a[0:3], a[68:71], v[48:51], a[0:3]
    v_mfma_f32_16x16x32_bf16 a[4:7], a[68:71], v[52:55], a[4:7]
    v_mfma_f32_16x16x32_bf16 a[8:11], a[68:71], v[56:59], a[8:11]
    v_mfma_f32_16x16x32_bf16 a[12:15], a[68:71], v[60:63], a[12:15]
    v_mfma_f32_16x16x32_bf16 a[16:19], a[76:79], v[48:51], a[16:19]
    v_mfma_f32_16x16x32_bf16 a[20:23], a[76:79], v[52:55], a[20:23]
    v_mfma_f32_16x16x32_bf16 a[24:27], a[76:79], v[56:59], a[24:27]
    v_mfma_f32_16x16x32_bf16 a[28:31], a[76:79], v[60:63], a[28:31]
    v_mfma_f32_16x16x32_bf16 a[32:35], a[84:87], v[48:51], a[32:35]
    v_mfma_f32_16x16x32_bf16 a[36:39], a[84:87], v[52:55], a[36:39]
    v_mfma_f32_16x16x32_bf16 a[40:43], a[84:87], v[56:59], a[40:43]
    v_mfma_f32_16x16x32_bf16 a[44:47], a[84:87], v[60:63], a[44:47]
    v_mfma_f32_16x16x32_bf16 a[48:51], a[92:95], v[48:51], a[48:51]
    v_mfma_f32_16x16x32_bf16 a[52:55], a[92:95], v[52:55], a[52:55]
    v_mfma_f32_16x16x32_bf16 a[56:59], a[92:95], v[56:59], a[56:59]
    v_mfma_f32_16x16x32_bf16 a[60:63], a[92:95], v[60:63], a[60:63]
    s_add_u32 s87, s87, 1
    s_cmp_ge_u32 s87, s90
    s_cbranch_scc1 L_mlpd
    s_waitcnt lgkmcnt(0)
    v_xor_b32 v16, v148, v4
    v_xor_b32 v17, v148, v15
    ds_read_b128 a[64:67], v16
    ds_read_b128 a[68:71], v17
    v_xor_b32 v18, v149, v4
    v_xor_b32 v19, v149, v15
    ds_read_b128 a[72:75], v18
    ds_read_b128 a[76:79], v19
    v_xor_b32 v20, v150, v4
    v_xor_b32 v21, v150, v15
    ds_read_b128 a[80:83], v20
    ds_read_b128 a[84:87], v21
    v_xor_b32 v22, v151, v4
    v_xor_b32 v23, v151, v15
    ds_read_b128 a[88:91], v22
    ds_read_b128 a[92:95], v23
    ds_read_b128 v[144:147], v9 offset:256
    v_add_u32 v9, 256, v9
    s_add_u32 s78, s87, 2
    s_cmp_ge_u32 s78, s90
    s_cselect_b32 s88, 0x40000000, s88
    s_waitcnt vmcnt(8)
    v_perm_b32 v32, v100, v96, s76
    v_perm_b32 v33, v108, v104, s76
    v_perm_b32 v36, v100, v96, s77
    v_perm_b32 v37, v108, v104, s77
    v_perm_b32 v40, v101, v97, s76
    v_perm_b32 v41, v109, v105, s76
    v_perm_b32 v44, v101, v97, s77
    v_perm_b32 v45, v109, v105, s77
    v_perm_b32 v128, v102, v98, s76
    v_perm_b32 v129, v110, v106, s76
    v_perm_b32 v130, v102, v98, s77
    v_perm_b32 v131, v110, v106, s77
    v_perm_b32 v132, v103, v99, s76
    v_perm_b32 v133, v111, v107, s76
    v_perm_b32 v134, v103, v99, s77
    v_perm_b32 v135, v111, v107, s77
    v_mov_b32_dpp v34, v32 row_shl:4 row_mask:0xf bank_mask:0x5
    v_mov_b32_dpp v35, v33 row_shl:4 row_mask:0xf bank_mask:0x5
    v_mov_b32_dpp v38, v36 row_shl:4 row_mask:0xf bank_mask:0x5
    v_mov_b32_dpp v39, v37 row_shl:4 row_mask:0xf bank_mask:0x5
    v_mov_b32_dpp v42, v40 row_shl:4 row_mask:0xf bank_mask:0x5
    v_mov_b32_dpp v43, v41 row_shl:4 row_mask:0xf bank_mask:0x5
    v_mov_b32_dpp v46, v44 row_shl:4 row_mask:0xf bank_mask:0x5
    v_mov_b32_dpp v47, v45 row_shl:4 row_mask:0xf bank_mask:0x5
    v_mov_b32_dpp v34, v128 quad_perm:[0,1,2,3] row_mask:0xf bank_mask:0xa
    v_mov_b32_dpp v35, v129 quad_perm:[0,1,2,3] row_mask:0xf bank_mask:0xa
    v_mov_b32_dpp v38, v130 quad_perm:[0,1,2,3] row_mask:0xf bank_mask:0xa
    v_mov_b32_dpp v39, v131 quad_perm:[0,1,2,3] row_mask:0xf bank_mask:0xa
    v_mov_b32_dpp v42, v132 quad_perm:[0,1,2,3] row_mask:0xf bank_mask:0xa
    v_mov_b32_dpp v43, v133 quad_perm:[0,1,2,3] row_mask:0xf bank_mask:0xa
    v_mov_b32_dpp v46, v134 quad_perm:[0,1,2,3] row_mask:0xf bank_mask:0xa
    v_mov_b32_dpp v47, v135 quad_perm:[0,1,2,3] row_mask:0xf bank_mask:0xa
    v_mov_b32_dpp v32, v128 row_shr:4 row_mask:0xf bank_mask:0xa
    v_mov_b32_dpp v33, v129 row_shr:4 row_mask:0xf bank_mask:0xa
    v_mov_b32_dpp v36, v130 row_shr:4 row_mask:0xf bank_mask:0xa
    v_mov_b32_dpp v37, v131 row_shr:4 row_mask:0xf bank_mask:0xa
    v_mov_b32_dpp v40, v132 row_shr:4 row_mask:0xf bank_mask:0xa
    v_mov_b32_dpp v41, v133 row_shr:4 row_mask:0xf bank_mask:0xa
    v_mov_b32_dpp v44, v134 row_shr:4 row_mask:0xf bank_mask:0xa
    v_mov_b32_dpp v45, v135 row_shr:4 row_mask:0xf bank_mask:0xa
    v_perm_b32 v48, v116, v112, s76
    v_perm_b32 v49, v124, v120, s76
    v_perm_b32 v52, v116, v112, s77
    v_perm_b32 v53, v124, v120, s77
    v_perm_b32 v56, v117, v113, s76
    v_perm_b32 v57, v125, v121, s76
    v_perm_b32 v60, v117, v113, s77
    v_perm_b32 v61, v125, v121, s77
    v_perm_b32 v128, v118, v114, s76
    v_perm_b32 v129, v126, v122, s76
    v_perm_b32 v130, v118, v114, s77
    v_perm_b32 v131, v126, v122, s77
    v_perm_b32 v132, v119, v115, s76
    v_perm_b32 v133, v127, v123, s76
    v_perm_b32 v134, v119, v115, s77
    v_perm_b32 v135, v127, v123, s77
    v_mov_b32_dpp v50, v48 row_shl:4 row_mask:0xf bank_mask:0x5
    v_mov_b32_dpp v51, v49 row_shl:4 row_mask:0xf bank_mask:0x5
    v_mov_b32_dpp v54, v52 row_shl:4 row_mask:0xf bank_mask:0x5
    v_mov_b32_dpp v55, v53 row_shl:4 row_mask:0xf bank_mask:0x5
    v_mov_b32_dpp v58, v56 row_shl:4 row_mask:0xf bank_mask:0x5
    v_mov_b32_dpp v59, v57 row_shl:4 row_mask:0xf bank_mask:0x5
    v_mov_b32_dpp v62, v60 row_shl:4 row_mask:0xf bank_mask:0x5
    v_mov_b32_dpp v63, v61 row_shl:4 row_mask:0xf bank_mask:0x5
    v_mov_b32_dpp v50, v128 quad_perm:[0,1,2,3] row_mask:0xf bank_mask:0xa
    v_mov_b32_dpp v51, v129 quad_perm:[0,1,2,3] row_mask:0xf bank_mask:0xa
    v_mov_b32_dpp v54, v130 quad_perm:[0,1,2,3] row_mask:0xf bank_mask:0xa
    v_mov_b32_dpp v55, v131 quad_perm:[0,1,2,3] row_mask:0xf bank_mask:0xa
    v_mov_b32_dpp v58, v132 quad_perm:[0,1,2,3] row_mask:0xf bank_mask:0xa
    v_mov_b32_dpp v59, v133 quad_perm:[0,1,2,3] row_mask:0xf bank_mask:0xa
    v_mov_b32_dpp v62, v134 quad_perm:[0,1,2,3] row_mask:0xf bank_mask:0xa
    v_mov_b32_dpp v63, v135 quad_perm:[0,1,2,3] row_mask:0xf bank_mask:0xa
    v_mov_b32_dpp v48, v128 row_shr:4 row_mask:0xf bank_mask:0xa
    v_mov_b32_dpp v49, v129 row_shr:4 row_mask:0xf bank_mask:0xa
    v_mov_b32_dpp v52, v130 row_shr:4 row_mask:0xf bank_mask:0xa
    v_mov_b32_dpp v53, v131 row_shr:4 row_mask:0xf bank_mask:0xa
    v_mov_b32_dpp v56, v132 row_shr:4 row_mask:0xf bank_mask:0xa
    v_mov_b32_dpp v57, v133 row_shr:4 row_mask:0xf bank_mask:0xa
    v_mov_b32_dpp v60, v134 row_shr:4 row_mask:0xf bank_mask:0xa
    v_mov_b32_dpp v61, v135 row_shr:4 row_mask:0xf bank_mask:0xa
    s_add_u32 s81, s88, 0
    buffer_load_dwordx4 v[96:99], v5, s[48:51], s81 offen offset:0
    buffer_load_dwordx4 v[100:103], v5, s[48:51], s81 offen offset:512
    buffer_load_dwordx4 v[104:107], v5, s[48:51], s81 offen offset:1024
    buffer_load_dwordx4 v[108:111], v5, s[48:51], s81 offen offset:1536
    s_add_u32 s81, s88, 16384
    buffer_load_dwordx4 v[112:115], v5, s[48:51], s81 offen offset:0
    buffer_load_dwordx4 v[116:119], v5, s[48:51], s81 offen offset:512
    buffer_load_dwordx4 v[120:123], v5, s[48:51], s81 offen offset:1024
    buffer_load_dwordx4 v[124:127], v5, s[48:51], s81 offen offset:1536
    s_add_u32 s88, s88, 32768
    s_waitcnt lgkmcnt(1)
    v_mfma_f32_16x16x32_bf16 a[0:3], a[64:67], v[32:35], a[0:3]
    v_mfma_f32_16x16x32_bf16 a[4:7], a[64:67], v[36:39], a[4:7]
    v_mfma_f32_16x16x32_bf16 a[8:11], a[64:67], v[40:43], a[8:11]
    v_mfma_f32_16x16x32_bf16 a[12:15], a[64:67], v[44:47], a[12:15]
    v_mfma_f32_16x16x32_bf16 a[16:19], a[72:75], v[32:35], a[16:19]
    v_mfma_f32_16x16x32_bf16 a[20:23], a[72:75], v[36:39], a[20:23]
    v_mfma_f32_16x16x32_bf16 a[24:27], a[72:75], v[40:43], a[24:27]
    v_mfma_f32_16x16x32_bf16 a[28:31], a[72:75], v[44:47], a[28:31]
    v_mfma_f32_16x16x32_bf16 a[32:35], a[80:83], v[32:35], a[32:35]
    v_mfma_f32_16x16x32_bf16 a[36:39], a[80:83], v[36:39], a[36:39]
    v_mfma_f32_16x16x32_bf16 a[40:43], a[80:83], v[40:43], a[40:43]
    v_mfma_f32_16x16x32_bf16 a[44:47], a[80:83], v[44:47], a[44:47]
    v_mfma_f32_16x16x32_bf16 a[48:51], a[88:91], v[32:35], a[48:51]
    v_mfma_f32_16x16x32_bf16 a[52:55], a[88:91], v[36:39], a[52:55]
    v_mfma_f32_16x16x32_bf16 a[56:59], a[88:91], v[40:43], a[56:59]
    v_mfma_f32_16x16x32_bf16 a[60:63], a[88:91], v[44:47], a[60:63]
    v_mfma_f32_16x16x32_bf16 a[0:3], a[68:71], v[48:51], a[0:3]
    v_mfma_f32_16x16x32_bf16 a[4:7], a[68:71], v[52:55], a[4:7]
    v_mfma_f32_16x16x32_bf16 a[8:11], a[68:71], v[56:59], a[8:11]
    v_mfma_f32_16x16x32_bf16 a[12:15], a[68:71], v[60:63], a[12:15]
    v_mfma_f32_16x16x32_bf16 a[16:19], a[76:79], v[48:51], a[16:19]
    v_mfma_f32_16x16x32_bf16 a[20:23], a[76:79], v[52:55], a[20:23]
    v_mfma_f32_16x16x32_bf16 a[24:27], a[76:79], v[56:59], a[24:27]
    v_mfma_f32_16x16x32_bf16 a[28:31], a[76:79], v[60:63], a[28:31]
    v_mfma_f32_16x16x32_bf16 a[32:35], a[84:87], v[48:51], a[32:35]
    v_mfma_f32_16x16x32_bf16 a[36:39], a[84:87], v[52:55], a[36:39]
    v_mfma_f32_16x16x32_bf16 a[40:43], a[84:87], v[56:59], a[40:43]
    v_mfma_f32_16x16x32_bf16 a[44:47], a[84:87], v[60:63], a[44:47]
    v_mfma_f32_16x16x32_bf16 a[48:51], a[92:95], v[48:51], a[48:51]
    v_mfma_f32_16x16x32_bf16 a[52:55], a[92:95], v[52:55], a[52:55]
    v_mfma_f32_16x16x32_bf16 a[56:59], a[92:95], v[56:59], a[56:59]
    v_mfma_f32_16x16x32_bf16 a[60:63], a[92:95], v[60:63], a[60:63]
    s_add_u32 s87, s87, 1
    s_cmp_ge_u32 s87, s90
    s_cbranch_scc0 L_mlp
L_mlpd:
    s_nop 7
    s_nop 7
    s_barrier
    v_lshlrev_b32 v6, 4, v1
    s_lshl_b32 s78, s5, 14
    v_add_u32 v7, s78, v6
    ds_write_b128 v7, a[0:3] offset:0
    ds_write_b128 v7, a[4:7] offset:1024
    ds_write_b128 v7, a[8:11] offset:2048
    ds_write_b128 v7, a[12:15] offset:3072
    ds_write_b128 v7, a[16:19] offset:4096
    ds_write_b128 v7, a[20:23] offset:5120
    ds_write_b128 v7, a[24:27] offset:6144
    ds_write_b128 v7, a[28:31] offset:7168
    ds_write_b128 v7, a[32:35] offset:8192
    ds_write_b128 v7, a[36:39] offset:9216
    ds_write_b128 v7, a[40:43] offset:10240
    ds_write_b128 v7, a[44:47] offset:11264
    ds_write_b128 v7, a[48:51] offset:12288
    ds_write_b128 v7, a[52:55] offset:13312
    ds_write_b128 v7, a[56:59] offset:14336
    ds_write_b128 v7, a[60:63] offset:15360
    s_waitcnt lgkmcnt(0)
    s_barrier
    s_cmp_ge_u32 s5, 4
    s_cbranch_scc1 L_skip
    s_lshl_b32 s78, s5, 12
    v_add_u32 v7, s78, v6
    v_add_u32 v9, 0x10000, v7
    ds_read_b128 v[32:35], v7 offset:0
    ds_read_b128 v[36:39], v7 offset:1024
    ds_read_b128 v[40:43], v7 offset:2048
    ds_read_b128 v[44:47], v7 offset:3072
    ds_read_b128 v[48:51], v7 offset:16384
    ds_read_b128 v[52:55], v7 offset:17408
    ds_read_b128 v[56:59], v7 offset:18432
    ds_read_b128 v[60:63], v7 offset:19456
    ds_read_b128 v[64:67], v7 offset:32768
    ds_read_b128 v[68:71], v7 offset:33792
    ds_read_b128 v[72:75], v7 offset:34816
    ds_read_b128 v[76:79], v7 offset:35840
    ds_read_b128 v[80:83], v7 offset:49152
    ds_read_b128 v[84:87], v7 offset:50176
    ds_read_b128 v[88:91], v7 offset:51200
    ds_read_b128 v[92:95], v7 offset:52224
    ds_read_b128 v[96:99], v9 offset:0
    ds_read_b128 v[100:103], v9 offset:1024
    ds_read_b128 v[104:107], v9 offset:2048
    ds_read_b128 v[108:111], v9 offset:3072
    ds_read_b128 v[112:115], v9 offset:16384
    ds_read_b128 v[116:119], v9 offset:17408
    ds_read_b128 v[120:123], v9 offset:18432
    ds_read_b128 v[124:127], v9 offset:19456
    s_waitcnt lgkmcnt(0)
    v_add_f32 v32, v32, v96
    v_add_f32 v33, v33, v97
    v_add_f32 v34, v34, v98
    v_add_f32 v35, v35, v99
    v_add_f32 v36, v36, v100
    v_add_f32 v37, v37, v101
    v_add_f32 v38, v38, v102
    v_add_f32 v39, v39, v103
    v_add_f32 v40, v40, v104
    v_add_f32 v41, v41, v105
    v_add_f32 v42, v42, v106
    v_add_f32 v43, v43, v107
    v_add_f32 v44, v44, v108
    v_add_f32 v45, v45, v109
    v_add_f32 v46, v46, v110
    v_add_f32 v47, v47, v111
    v_add_f32 v48, v48, v112
    v_add_f32 v49, v49, v113
    v_add_f32 v50, v50, v114
    v_add_f32 v51, v51, v115
    v_add_f32 v52, v52, v116
    v_add_f32 v53, v53, v117
    v_add_f32 v54, v54, v118
    v_add_f32 v55, v55, v119
    v_add_f32 v56, v56, v120
    v_add_f32 v57, v57, v121
    v_add_f32 v58, v58, v122
    v_add_f32 v59, v59, v123
    v_add_f32 v60, v60, v124
    v_add_f32 v61, v61, v125
    v_add_f32 v62, v62, v126
    v_add_f32 v63, v63, v127
    ds_read_b128 v[96:99], v9 offset:32768
    ds_read_b128 v[100:103], v9 offset:33792
    ds_read_b128 v[104:107], v9 offset:34816
    ds_read_b128 v[108:111], v9 offset:35840
    ds_read_b128 v[112:115], v9 offset:49152
    ds_read_b128 v[116:119], v9 offset:50176
    ds_read_b128 v[120:123], v9 offset:51200
    ds_read_b128 v[124:127], v9 offset:52224
    s_waitcnt lgkmcnt(0)
    v_add_f32 v64, v64, v96
    v_add_f32 v65, v65, v97
    v_add_f32 v66, v66, v98
    v_add_f32 v67, v67, v99
    v_add_f32 v68, v68, v100
    v_add_f32 v69, v69, v101
    v_add_f32 v70, v70, v102
    v_add_f32 v71, v71, v103
    v_add_f32 v72, v72, v104
    v_add_f32 v73, v73, v105
    v_add_f32 v74, v74, v106
    v_add_f32 v75, v75, v107
    v_add_f32 v76, v76, v108
    v_add_f32 v77, v77, v109
    v_add_f32 v78, v78, v110
    v_add_f32 v79, v79, v111
    v_add_f32 v80, v80, v112
    v_add_f32 v81, v81, v113
    v_add_f32 v82, v82, v114
    v_add_f32 v83, v83, v115
    v_add_f32 v84, v84, v116
    v_add_f32 v85, v85, v117
    v_add_f32 v86, v86, v118
    v_add_f32 v87, v87, v119
    v_add_f32 v88, v88, v120
    v_add_f32 v89, v89, v121
    v_add_f32 v90, v90, v122
    v_add_f32 v91, v91, v123
    v_add_f32 v92, v92, v124
    v_add_f32 v93, v93, v125
    v_add_f32 v94, v94, v126
    v_add_f32 v95, v95, v127
    v_lshlrev_b32 v96, 16, v156
    v_and_b32 v97, 0xffff0000, v156
    v_lshlrev_b32 v98, 16, v157
    v_and_b32 v99, 0xffff0000, v157
    v_lshlrev_b32 v100, 16, v158
    v_and_b32 v101, 0xffff0000, v158
    v_lshlrev_b32 v102, 16, v159
    v_and_b32 v103, 0xffff0000, v159
    v_mov_b32 v8, s82
    s_waitcnt lgkmcnt(0)
    v_add_f32 v32, v32, v48
    v_add_f32 v108, v64, v80
    v_add_f32 v32, v32, v96
    v_add_f32 v32, v32, v108
    v_add_f32 v33, v33, v49
    v_add_f32 v109, v65, v81
    v_add_f32 v33, v33, v96
    v_add_f32 v33, v33, v109
    v_add_f32 v34, v34, v50
    v_add_f32 v110, v66, v82
    v_add_f32 v34, v34, v96
    v_add_f32 v34, v34, v110
    v_add_f32 v35, v35, v51
    v_add_f32 v111, v67, v83
    v_add_f32 v35, v35, v96
    v_add_f32 v35, v35, v111
    v_mul_f32 v108, v32, v32
    v_fma_f32 v108, v108, s83, v8
    v_mul_f32 v108, v108, v32
    v_mul_f32 v109, v33, v33
    v_fma_f32 v109, v109, s83, v8
    v_mul_f32 v109, v109, v33
    v_mul_f32 v110, v34, v34
    v_fma_f32 v110, v110, s83, v8
    v_mul_f32 v110, v110, v34
    v_mul_f32 v111, v35, v35
    v_fma_f32 v111, v111, s83, v8
    v_mul_f32 v111, v111, v35
    v_exp_f32 v108, v108
    v_exp_f32 v109, v109
    v_exp_f32 v110, v110
    v_exp_f32 v111, v111
    v_add_f32 v108, 1.0, v108
    v_add_f32 v109, 1.0, v109
    v_add_f32 v110, 1.0, v110
    v_add_f32 v111, 1.0, v111
    v_rcp_f32 v108, v108
    v_rcp_f32 v109, v109
    v_rcp_f32 v110, v110
    v_rcp_f32 v111, v111
    v_mul_f32 v32, v32, v108
    v_mul_f32 v33, v33, v109
    v_mul_f32 v34, v34, v110
    v_mul_f32 v35, v35, v111
    v_mul_f32 v104, v32, v100
    v_mul_f32 v105, v33, v100
    v_mul_f32 v106, v34, v100
    v_mul_f32 v107, v35, v100
    v_add_f32 v36, v36, v52
    v_add_f32 v108, v68, v84
    v_add_f32 v36, v36, v97
    v_add_f32 v36, v36, v108
    v_add_f32 v37, v37, v53
    v_add_f32 v109, v69, v85
    v_add_f32 v37, v37, v97
    v_add_f32 v37, v37, v109
    v_add_f32 v38, v38, v54
    v_add_f32 v110, v70, v86
    v_add_f32 v38, v38, v97
    v_add_f32 v38, v38, v110
    v_add_f32 v39, v39, v55
    v_add_f32 v111, v71, v87
    v_add_f32 v39, v39, v97
    v_add_f32 v39, v39, v111
    v_mul_f32 v108, v36, v36
    v_fma_f32 v108, v108, s83, v8
    v_mul_f32 v108, v108, v36
    v_mul_f32 v109, v37, v37
    v_fma_f32 v109, v109, s83, v8
    v_mul_f32 v109, v109, v37
    v_mul_f32 v110, v38, v38
    v_fma_f32 v110, v110, s83, v8
    v_mul_f32 v110, v110, v38
    v_mul_f32 v111, v39, v39
    v_fma_f32 v111, v111, s83, v8
    v_mul_f32 v111, v111, v39
    v_exp_f32 v108, v108
    v_exp_f32 v109, v109
    v_exp_f32 v110, v110
    v_exp_f32 v111, v111
    v_add_f32 v108, 1.0, v108
    v_add_f32 v109, 1.0, v109
    v_add_f32 v110, 1.0, v110
    v_add_f32 v111, 1.0, v111
    v_rcp_f32 v108, v108
    v_rcp_f32 v109, v109
    v_rcp_f32 v110, v110
    v_rcp_f32 v111, v111
    v_mul_f32 v36, v36, v108
    v_mul_f32 v37, v37, v109
    v_mul_f32 v38, v38, v110
    v_mul_f32 v39, v39, v111
    v_fmac_f32 v104, v36, v101
    v_fmac_f32 v105, v37, v101
    v_fmac_f32 v106, v38, v101
    v_fmac_f32 v107, v39, v101
    v_add_f32 v40, v40, v56
    v_add_f32 v108, v72, v88
    v_add_f32 v40, v40, v98
    v_add_f32 v40, v40, v108
    v_add_f32 v41, v41, v57
    v_add_f32 v109, v73, v89
    v_add_f32 v41, v41, v98
    v_add_f32 v41, v41, v109
    v_add_f32 v42, v42, v58
    v_add_f32 v110, v74, v90
    v_add_f32 v42, v42, v98
    v_add_f32 v42, v42, v110
    v_add_f32 v43, v43, v59
    v_add_f32 v111, v75, v91
    v_add_f32 v43, v43, v98
    v_add_f32 v43, v43, v111
    v_mul_f32 v108, v40, v40
    v_fma_f32 v108, v108, s83, v8
    v_mul_f32 v108, v108, v40
    v_mul_f32 v109, v41, v41
    v_fma_f32 v109, v109, s83, v8
    v_mul_f32 v109, v109, v41
    v_mul_f32 v110, v42, v42
    v_fma_f32 v110, v110, s83, v8
    v_mul_f32 v110, v110, v42
    v_mul_f32 v111, v43, v43
    v_fma_f32 v111, v111, s83, v8
    v_mul_f32 v111, v111, v43
    v_exp_f32 v108, v108
    v_exp_f32 v109, v109
    v_exp_f32 v110, v110
    v_exp_f32 v111, v111
    v_add_f32 v108, 1.0, v108
    v_add_f32 v109, 1.0, v109
    v_add_f32 v110, 1.0, v110
    v_add_f32 v111, 1.0, v111
    v_rcp_f32 v108, v108
    v_rcp_f32 v109, v109
    v_rcp_f32 v110, v110
    v_rcp_f32 v111, v111
    v_mul_f32 v40, v40, v108
    v_mul_f32 v41, v41, v109
    v_mul_f32 v42, v42, v110
    v_mul_f32 v43, v43, v111
    v_fmac_f32 v104, v40, v102
    v_fmac_f32 v105, v41, v102
    v_fmac_f32 v106, v42, v102
    v_fmac_f32 v107, v43, v102
    v_add_f32 v44, v44, v60
    v_add_f32 v108, v76, v92
    v_add_f32 v44, v44, v99
    v_add_f32 v44, v44, v108
    v_add_f32 v45, v45, v61
    v_add_f32 v109, v77, v93
    v_add_f32 v45, v45, v99
    v_add_f32 v45, v45, v109
    v_add_f32 v46, v46, v62
    v_add_f32 v110, v78, v94
    v_add_f32 v46, v46, v99
    v_add_f32 v46, v46, v110
    v_add_f32 v47, v47, v63
    v_add_f32 v111, v79, v95
    v_add_f32 v47, v47, v99
    v_add_f32 v47, v47, v111
    v_mul_f32 v108, v44, v44
    v_fma_f32 v108, v108, s83, v8
    v_mul_f32 v108, v108, v44
    v_mul_f32 v109, v45, v45
    v_fma_f32 v109, v109, s83, v8
    v_mul_f32 v109, v109, v45
    v_mul_f32 v110, v46, v46
    v_fma_f32 v110, v110, s83, v8
    v_mul_f32 v110, v110, v46
    v_mul_f32 v111, v47, v47
    v_fma_f32 v111, v111, s83, v8
    v_mul_f32 v111, v111, v47
    v_exp_f32 v108, v108
    v_exp_f32 v109, v109
    v_exp_f32 v110, v110
    v_exp_f32 v111, v111
    v_add_f32 v108, 1.0, v108
    v_add_f32 v109, 1.0, v109
    v_add_f32 v110, 1.0, v110
    v_add_f32 v111, 1.0, v111
    v_rcp_f32 v108, v108
    v_rcp_f32 v109, v109
    v_rcp_f32 v110, v110
    v_rcp_f32 v111, v111
    v_mul_f32 v44, v44, v108
    v_mul_f32 v45, v45, v109
    v_mul_f32 v46, v46, v110
    v_mul_f32 v47, v47, v111
    v_fmac_f32 v104, v44, v103
    v_fmac_f32 v105, v45, v103
    v_fmac_f32 v106, v46, v103
    v_fmac_f32 v107, v47, v103
    s_nop 1
    v_add_f32_dpp v104, v104, v104 row_shr:1 row_mask:0xf bank_mask:0xf bound_ctrl:0
    s_nop 1
    v_add_f32_dpp v105, v105, v105 row_shr:1 row_mask:0xf bank_mask:0xf bound_ctrl:0
    s_nop 1
    v_add_f32_dpp v106, v106, v106 row_shr:1 row_mask:0xf bank_mask:0xf bound_ctrl:0
    s_nop 1
    v_add_f32_dpp v107, v107, v107 row_shr:1 row_mask:0xf bank_mask:0xf bound_ctrl:0
    s_nop 1
    v_add_f32_dpp v104, v104, v104 row_shr:2 row_mask:0xf bank_mask:0xf bound_ctrl:0
    s_nop 1
    v_add_f32_dpp v105, v105, v105 row_shr:2 row_mask:0xf bank_mask:0xf bound_ctrl:0
    s_nop 1
    v_add_f32_dpp v106, v106, v106 row_shr:2 row_mask:0xf bank_mask:0xf bound_ctrl:0
    s_nop 1
    v_add_f32_dpp v107, v107, v107 row_shr:2 row_mask:0xf bank_mask:0xf bound_ctrl:0
    s_nop 1
    v_add_f32_dpp v104, v104, v104 row_shr:4 row_mask:0xf bank_mask:0xf bound_ctrl:0
    s_nop 1
    v_add_f32_dpp v105, v105, v105 row_shr:4 row_mask:0xf bank_mask:0xf bound_ctrl:0
    s_nop 1
    v_add_f32_dpp v106, v106, v106 row_shr:4 row_mask:0xf bank_mask:0xf bound_ctrl:0
    s_nop 1
    v_add_f32_dpp v107, v107, v107 row_shr:4 row_mask:0xf bank_mask:0xf bound_ctrl:0
    s_nop 1
    v_add_f32_dpp v104, v104, v104 row_shr:8 row_mask:0xf bank_mask:0xf bound_ctrl:0
    s_nop 1
    v_add_f32_dpp v105, v105, v105 row_shr:8 row_mask:0xf bank_mask:0xf bound_ctrl:0
    s_nop 1
    v_add_f32_dpp v106, v106, v106 row_shr:8 row_mask:0xf bank_mask:0xf bound_ctrl:0
    s_nop 1
    v_add_f32_dpp v107, v107, v107 row_shr:8 row_mask:0xf bank_mask:0xf bound_ctrl:0
    s_lshl_b32 s78, s2, 8
    s_lshl_b32 s79, s5, 6
    s_add_u32 s78, s78, s79
    v_lshlrev_b32 v9, 4, v3
    s_mov_b64 s[84:85], exec
    s_mov_b32 exec_lo, 0x80008000
    s_mov_b32 exec_hi, 0x80008000
    buffer_store_dwordx4 v[104:107], v9, s[60:63], s78 offen
    s_mov_b64 exec, s[84:85]
L_skip:
L_end:
s_endpgm
.globl fin_kernel
.p2align 8
.type fin_kernel,@function
fin_kernel:
    s_cmp_ge_u32 s2, 16
    s_cbranch_scc1 L_fend
    s_load_dwordx2 s[4:5], s[0:1], 48
    s_load_dwordx2 s[6:7], s[0:1], 56
    s_load_dwordx2 s[8:9], s[0:1], 72
    s_lshl_b32 s3, s2, 8
    v_add_u32 v1, s3, v0
    v_lshrrev_b32 v2, 6, v1
    v_and_b32 v3, 63, v1
    v_lshlrev_b32 v2, 10, v2
    v_lshl_add_u32 v2, v3, 2, v2
    v_lshlrev_b32 v4, 2, v1
    v_lshlrev_b32 v5, 1, v1
    v_mov_b32 v6, 0
    s_waitcnt lgkmcnt(0)
    s_mov_b32 s12, s8
    s_and_b32 s13, s9, 0xffff
    s_mov_b32 s14, 81920
    s_mov_b32 s15, 0x00020000
    s_mov_b32 s16, s4
    s_and_b32 s17, s5, 0xffff
    s_mov_b32 s18, 2
    s_mov_b32 s19, 0x00020000
    s_mov_b32 s20, s6
    s_and_b32 s21, s7, 0xffff
    s_mov_b32 s22, 8192
    s_mov_b32 s23, 0x00020000
    s_mov_b32 s24, 65536
    buffer_load_dword v8, v2, s[12:15], 0 offen
    buffer_load_dword v9, v2, s[12:15], 0 offen offset:256
    buffer_load_dword v10, v2, s[12:15], 0 offen offset:512
    buffer_load_dword v11, v2, s[12:15], 0 offen offset:768
    buffer_load_dword v12, v4, s[12:15], s24 offen
    buffer_load_ushort v13, v6, s[16:19], 0 offen
    s_waitcnt vmcnt(0)
    v_lshlrev_b32 v13, 16, v13
    v_add_f32 v8, v8, v9
    v_add_f32 v10, v10, v11
    v_add_f32 v8, v8, v10
    v_add_f32 v8, v8, v13
    v_add_f32 v8, v8, v12
    v_cvt_pk_bf16_f32 v8, v8, v8
    buffer_store_short v8, v5, s[20:23], 0 offen
L_fend:
s_endpgm
.section .rodata,"a"
.p2align 6
.amdhsa_kernel fin_kernel
  .amdhsa_next_free_vgpr 16
  .amdhsa_next_free_sgpr 32
  .amdhsa_accum_offset 16
  .amdhsa_group_segment_fixed_size 0
  .amdhsa_kernarg_size 80
  .amdhsa_user_sgpr_count 2
  .amdhsa_user_sgpr_kernarg_segment_ptr 1
  .amdhsa_system_sgpr_workgroup_id_x 1
.end_amdhsa_kernel
.p2align 6
.amdhsa_kernel standalone__deep_cross_pnn__recsys_kernel
  .amdhsa_next_free_vgpr 256
  .amdhsa_next_free_sgpr 102
  .amdhsa_accum_offset 160
  .amdhsa_group_segment_fixed_size 0
  .amdhsa_kernarg_size 80
  .amdhsa_user_sgpr_count 2
  .amdhsa_user_sgpr_kernarg_segment_ptr 1
  .amdhsa_system_sgpr_workgroup_id_x 1
.end_amdhsa_kernel
```
